```python
import torch

def _softmax(x, axis=-1):
    return torch.softmax(x, dim=axis)
def _gelu(x):
    return torch.nn.functional.gelu(x, approximate="tanh")
def _silu(x):
    return torch.nn.functional.silu(x)
def _sigmoid(x):
    return torch.sigmoid(x)
def _layernorm(x, axis=-1, eps=1e-5):
    m = x.mean(dim=axis, keepdim=True)
    v = x.var(dim=axis, keepdim=True, unbiased=False)
    return (x - m) / torch.sqrt(v + eps)
def _scatter_add(tgt, idx, src, axis=0):
    return tgt.clone().index_add_(axis, idx, src)
def _segment_sum(src, seg, n):
    out = torch.zeros((n,) + src.shape[1:], dtype=src.dtype)
    return out.index_add_(0, seg, src)
def _pad(x, pw):
    flat = tuple(v for pair in reversed(pw) for v in pair)
    return torch.nn.functional.pad(x, flat)

kernel_name = 'parallel_sum__gqa_block_cached__geglu_ffn__decode'

def setup_inputs():

    _w = (lambda a: (lambda t: t.to(torch.bfloat16) if t.is_floating_point() else t)(torch.as_tensor(a)))
    def _A_setup():
        B, Sq, D = 2, 1, 640
        Hq, Hkv, Sk, Dh = 32, 32, 4096, 128
        assert Hq % Hkv == 0, (Hq, Hkv)
        return {
            "x": _w((lambda *s: torch.randn(*s, dtype=torch.bfloat16) * 0.05)(B, Sq, D)),
            "k_cache": _w((lambda *s: torch.randn(*s, dtype=torch.bfloat16) * 3.2)(B, Hkv, Sk, Dh)),
            "v_cache": _w((lambda *s: torch.randn(*s, dtype=torch.bfloat16) * 1.6)(B, Hkv, Sk, Dh)),
            "wq": _w((lambda *s: torch.randn(*s, dtype=torch.bfloat16) * 3.2)(D, Hq * Dh) * (D ** -0.5)),
            "wo": _w((lambda *s: torch.randn(*s, dtype=torch.bfloat16) * 1.6)(Hq * Dh, D) * ((Hq * Dh) ** -0.5)),
        }
    _A_in = _A_setup()

    def _B_setup():
        B, S, D, F = 2, 1, 640, 1728
        return {
            "x": _w((lambda *s: torch.randn(*s, dtype=torch.bfloat16) * 0.05)(B, S, D)),
            "w_gate": _w((lambda *s: torch.randn(*s, dtype=torch.bfloat16) * 0.05)(D, F)),
            "w_up": _w((lambda *s: torch.randn(*s, dtype=torch.bfloat16) * 0.05)(D, F)),
            "w_down": _w((lambda *s: torch.randn(*s, dtype=torch.bfloat16) * 0.05)(F, D)),
        }
    _B_in = _B_setup()

    return {
        "A_x": _A_in["x"],
        "A_k_cache": _A_in["k_cache"],
        "A_v_cache": _A_in["v_cache"],
        "A_wq": _A_in["wq"],
        "A_wo": _A_in["wo"],
        "B_x": _B_in["x"],
        "B_w_gate": _B_in["w_gate"],
        "B_w_up": _B_in["w_up"],
        "B_w_down": _B_in["w_down"],
    }

def reference(A_x, A_k_cache, A_v_cache, A_wq, A_wo, B_x, B_w_gate, B_w_up, B_w_down):
    def _A_ref(x, k_cache, v_cache, wq, wo):
        B, Sq, D = x.shape
        Hq, Dh = 32, 128
        Hkv = k_cache.shape[1]
        rep = Hq // Hkv
        q = (lambda x, *d: x.permute(*d))((x @ wq).reshape(B, Sq, Hq, Dh), 0, 2, 1, 3)
        k = (lambda x, n, axis: torch.repeat_interleave(x, n, dim=axis))(k_cache, rep, axis=1)
        v = (lambda x, n, axis: torch.repeat_interleave(x, n, dim=axis))(v_cache, rep, axis=1)
        scores = torch.einsum("bhqd,bhkd->bhqk", q, k) * (Dh ** -0.5)
        p = _softmax(scores, axis=-1)
        o = torch.einsum("bhqk,bhkd->bhqd", p, v)
        return (lambda x, *d: x.permute(*d))(o, 0, 2, 1, 3).reshape(B, Sq, Hq * Dh) @ wo

    def _B_ref(x, w_gate, w_up, w_down):
        return (_gelu(x @ w_gate) * (x @ w_up)) @ w_down

    x = A_x
    xn = _layernorm(x, axis=-1)
    return x + _A_ref(xn, A_k_cache, A_v_cache, A_wq, A_wo) + _B_ref(xn, B_w_gate, B_w_up, B_w_down)
```

```asm
; @launch grid=(256,1,1) block=(512,1,1) lds=33920
.amdgcn_target "amdgcn-amd-amdhsa--gfx950"
.text
.globl parallel_sum__gqa_block_cached__geglu_ffn__decode_kernel
.p2align 8
.type parallel_sum__gqa_block_cached__geglu_ffn__decode_kernel,@function
parallel_sum__gqa_block_cached__geglu_ffn__decode_kernel:
    s_cmp_ge_u32 s2, 256
    s_cbranch_scc1 L_end
    s_load_dwordx16 s[4:19], s[0:1], 0
    s_load_dwordx8 s[20:27], s[0:1], 64
    v_lshrrev_b32 v3, 6, v0
    v_and_b32 v1, 63, v0
    v_readfirstlane_b32 s56, v3
    v_lshlrev_b32 v2, 4, v1
    s_and_b32 s57, s2, 7
    s_lshl_b32 s57, s57, 2
    s_lshr_b32 s61, s2, 3
    s_and_b32 s62, s61, 3
    s_add_u32 s57, s57, s62
    s_lshr_b32 s58, s2, 7
    s_lshr_b32 s59, s2, 5
    s_and_b32 s59, s59, 3
    s_lshl_b32 s81, s58, 5
    s_add_u32 s81, s81, s57
    s_lshl_b32 s64, s81, 20
    s_lshl_b32 s62, s59, 18
    s_add_u32 s64, s64, s62
    s_lshr_b32 s62, s56, 2
    s_lshl_b32 s62, s62, 17
    s_add_u32 s64, s64, s62
    s_and_b32 s69, s56, 3
    s_lshl_b32 s62, s69, 10
    s_add_u32 s64, s64, s62
    s_mov_b32 s65, s64
    s_mov_b32 s82, 0
    s_mov_b32 s30, 0x4000000
    s_mov_b32 s31, 0x20000
    s_waitcnt lgkmcnt(0)
    s_mov_b32 s28, s6
    s_mov_b32 s29, s7
    buffer_load_dwordx4 v[48:51], v2, s[28:31], s64 offen nt
    s_add_u32 s64, s64, 4096
    buffer_load_dwordx4 v[52:55], v2, s[28:31], s64 offen nt
    s_add_u32 s64, s64, 4096
    buffer_load_dwordx4 v[56:59], v2, s[28:31], s64 offen nt
    s_add_u32 s64, s64, 4096
    buffer_load_dwordx4 v[60:63], v2, s[28:31], s64 offen nt
    s_add_u32 s64, s64, 4096
    buffer_load_dwordx4 v[64:67], v2, s[28:31], s64 offen nt
    s_add_u32 s64, s64, 4096
    buffer_load_dwordx4 v[68:71], v2, s[28:31], s64 offen nt
    s_add_u32 s64, s64, 4096
    v_lshrrev_b32 v3, 4, v1
    v_and_b32 v4, 15, v1
    s_bfe_u32 s63, s2, 0x20003
    s_lshr_b32 s60, s2, 5
    s_lshl_b32 s60, s60, 3
    s_bfe_u32 s62, s2, 0x20001
    s_or_b32 s60, s60, s62
    s_and_b32 s62, s2, 1
    s_lshl_b32 s62, s62, 2
    s_or_b32 s60, s60, s62
    s_mov_b32 s62, s60
    s_cmp_eq_u32 s62, 39
    s_cselect_b32 s60, 59, s60
    s_cmp_eq_u32 s62, 59
    s_cselect_b32 s60, 39, s60
    s_cmp_eq_u32 s62, 47
    s_cselect_b32 s60, 60, s60
    s_cmp_eq_u32 s62, 60
    s_cselect_b32 s60, 47, s60
    s_cmp_eq_u32 s62, 55
    s_cselect_b32 s60, 61, s60
    s_cmp_eq_u32 s62, 61
    s_cselect_b32 s60, 55, s60
    s_cmp_lt_u32 s60, 32
    s_cselect_b32 s14, 1, 0
    s_mov_b32 s79, 0
    s_mov_b32 s78, 3456
    s_cselect_b32 s78, 8192, s78
    s_cselect_b32 s76, 8, 7
    s_cselect_b32 s77, 15, 7
    s_and_b32 s74, s60, 31
    s_sub_u32 s66, 58, s60
    s_cselect_b32 s67, 0, 1
    s_lshl_b32 s71, s60, 2
    s_add_u32 s71, s71, s63
    s_mul_i32 s75, s60, 32256
    s_lshl_b32 s62, s63, 10
    s_add_u32 s75, s75, s62
    s_mov_b32 s70, 10
    s_mov_b32 s68, 0
    s_lshl_b32 s62, s63, 2
    s_add_u32 s62, s62, s69
    s_mul_i32 s62, s62, s70
    s_lshl_b32 s62, s62, 2
    s_add_u32 s68, s68, s62
    v_mov_b32 v37, s68
    v_mad_u32_u24 v22, v3, s70, v37
    v_mul_lo_u32 v36, v22, s78
    s_lshl_b32 s62, s74, s76
    v_and_b32 v37, s77, v1
    v_lshl_add_u32 v36, v37, 4, v36
    v_add_u32 v36, s62, v36
    v_mov_b32 v37, 0
    v_and_b32 v38, 8, v1
    v_cmp_eq_u32 vcc, 0, v38
    s_lshr_b32 s83, s2, 1
    s_cmp_lt_u32 s83, 80
    s_cselect_b32 s61, 5, 0
    s_sub_u32 s71, s71, 240
    s_cmp_lt_u32 s71, 7
    s_cselect_b32 s61, 3, s61
    s_cselect_b32 s62, s71, 0
    s_cselect_b32 s83, 128, s83
    s_add_u32 s83, s83, s62
    s_bitcmp0_b32 s2, 0
    s_cselect_b32 s61, 3, s61
    s_cmp_eq_u32 s61, 3
    s_cselect_b32 s62, 7, 3
    s_cmp_eq_u32 s56, s62
    s_cselect_b32 s3, s61, 0
    s_cmp_eq_u32 s56, 0
    s_cselect_b32 s3, 1, s3
    s_cmp_eq_u32 s56, 2
    s_cselect_b32 s3, 2, s3
    s_cmp_ge_u32 s56, 4
    s_cselect_b32 s67, s67, 0
    v_mov_b32 v40, -1
    v_mov_b32 v41, -1
    v_mov_b32 v42, -1
    v_mov_b32 v43, -1
    s_mov_b32 s40, s26
    s_mov_b32 s41, s27
    s_mov_b32 s42, 0x1f8000
    s_mov_b32 s43, 0x20000
    s_mov_b32 s101, 2032128
    s_cmp_eq_u32 s67, 1
    s_cbranch_scc0 L_pref
    s_setprio 3
    v_lshrrev_b32 v38, 5, v1
    v_mul_u32_u24 v38, 1280, v38
    v_and_b32 v39, 31, v1
    v_lshl_add_u32 v12, v39, 3, v38
    s_cmp_lg_u32 s56, 4
    s_cbranch_scc1 L_noe
    buffer_load_dword v20, v37, s[40:43], s101 offen sc1
L_noe:
    s_cmp_lg_u32 s56, 5
    s_cbranch_scc1 L_nox
    s_mov_b32 s48, s4
    s_mov_b32 s49, s5
    s_mov_b32 s50, 0xa00
    s_mov_b32 s51, 0x20000
    buffer_load_dwordx2 v[24:25], v12, s[48:51], 0 offen offset:0
    buffer_load_dwordx2 v[26:27], v12, s[48:51], 0 offen offset:256
    buffer_load_dwordx2 v[28:29], v12, s[48:51], 0 offen offset:512
    buffer_load_dwordx2 v[30:31], v12, s[48:51], 0 offen offset:768
    buffer_load_dwordx2 v[32:33], v12, s[48:51], 0 offen offset:1024
L_nox:
    s_cmp_eq_u32 s14, 1
    s_cselect_b32 s61, s10, s16
    s_cselect_b32 s62, s11, s17
    s_cselect_b32 s72, s10, s18
    s_cselect_b32 s73, s11, s19
    v_mov_b32 v38, s72
    v_mov_b32 v39, s61
    v_cndmask_b32 v10, v38, v39, vcc
    v_mov_b32 v38, s73
    v_mov_b32 v39, s62
    v_cndmask_b32 v11, v38, v39, vcc
    v_lshl_add_u64 v[10:11], v[36:37], 0, v[10:11]
    global_load_dwordx4 v[176:179], v[10:11], off nt
    v_lshl_add_u64 v[10:11], v[10:11], 0, s[78:79]
    global_load_dwordx4 v[180:183], v[10:11], off nt
    v_lshl_add_u64 v[10:11], v[10:11], 0, s[78:79]
    global_load_dwordx4 v[184:187], v[10:11], off nt
    v_lshl_add_u64 v[10:11], v[10:11], 0, s[78:79]
    global_load_dwordx4 v[188:191], v[10:11], off nt
    v_lshl_add_u64 v[10:11], v[10:11], 0, s[78:79]
    global_load_dwordx4 v[192:195], v[10:11], off nt
    v_lshl_add_u64 v[10:11], v[10:11], 0, s[78:79]
    global_load_dwordx4 v[196:199], v[10:11], off nt
    v_lshl_add_u64 v[10:11], v[10:11], 0, s[78:79]
    global_load_dwordx4 v[200:203], v[10:11], off nt
    v_lshl_add_u64 v[10:11], v[10:11], 0, s[78:79]
    global_load_dwordx4 v[204:207], v[10:11], off nt
    v_lshl_add_u64 v[10:11], v[10:11], 0, s[78:79]
    global_load_dwordx4 v[208:211], v[10:11], off nt
    v_lshl_add_u64 v[10:11], v[10:11], 0, s[78:79]
    global_load_dwordx4 v[212:215], v[10:11], off nt
L_w8:
    s_lshl_b32 s61, s69, 10
    v_add_u32 v13, s61, v2
    ds_write_b128 v13, v[40:43] offset:25344
    ds_write_b128 v13, v[40:43] offset:29440
    s_waitcnt lgkmcnt(0)
    s_barrier
    s_mov_b32 s82, 1
    s_branch L_unit2
L_pref:
    s_setprio 2
    s_bitcmp1_b32 s82, 0
    s_cbranch_scc1 L_nobar0
    v_mov_b32 v37, -1
    v_lshlrev_b32 v36, 2, v1
    ds_write_b32 v36, v37 offset:0
    ds_write_b32 v36, v37 offset:256
    v_mov_b32 v36, 0
    ds_write_b32 v36, v36 offset:33856
    s_waitcnt lgkmcnt(0)
    s_barrier
    v_and_b32 v36, 1, v1
    v_lshlrev_b32 v36, 4, v36
    v_mov_b32 v37, 0xffff
    v_lshlrev_b32 v36, v36, v37
    v_bfe_u32 v37, v1, 1, 2
    v_cmp_eq_u32 vcc, 0, v37
    s_nop 1
    v_cndmask_b32 v6, 0, v36, vcc
    v_cmp_eq_u32 vcc, 1, v37
    s_nop 1
    v_cndmask_b32 v7, 0, v36, vcc
    v_cmp_eq_u32 vcc, 2, v37
    s_nop 1
    v_cndmask_b32 v8, 0, v36, vcc
    v_cmp_eq_u32 vcc, 3, v37
    s_nop 1
    v_cndmask_b32 v9, 0, v36, vcc
L_nobar0:
    buffer_load_dwordx4 v[72:75], v2, s[28:31], s64 offen nt
    s_add_u32 s64, s64, 4096
    buffer_load_dwordx4 v[76:79], v2, s[28:31], s64 offen nt
    s_add_u32 s64, s64, 4096
    buffer_load_dwordx4 v[80:83], v2, s[28:31], s64 offen nt
    s_add_u32 s64, s64, 4096
    buffer_load_dwordx4 v[84:87], v2, s[28:31], s64 offen nt
    s_add_u32 s64, s64, 4096
    buffer_load_dwordx4 v[88:91], v2, s[28:31], s64 offen nt
    s_add_u32 s64, s64, 4096
    buffer_load_dwordx4 v[92:95], v2, s[28:31], s64 offen nt
    s_add_u32 s64, s64, 4096
    buffer_load_dwordx4 v[96:99], v2, s[28:31], s64 offen nt
    s_add_u32 s64, s64, 4096
    buffer_load_dwordx4 v[100:103], v2, s[28:31], s64 offen nt
    s_add_u32 s64, s64, 4096
    buffer_load_dwordx4 v[104:107], v2, s[28:31], s64 offen nt
    s_add_u32 s64, s64, 4096
    buffer_load_dwordx4 v[108:111], v2, s[28:31], s64 offen nt
    s_add_u32 s64, s64, 4096
    buffer_load_dwordx4 v[112:115], v2, s[28:31], s64 offen nt
    s_add_u32 s64, s64, 4096
    buffer_load_dwordx4 v[116:119], v2, s[28:31], s64 offen nt
    s_add_u32 s64, s64, 4096
    buffer_load_dwordx4 v[120:123], v2, s[28:31], s64 offen nt
    s_add_u32 s64, s64, 4096
    buffer_load_dwordx4 v[124:127], v2, s[28:31], s64 offen nt
    s_add_u32 s64, s64, 4096
    s_cmp_lg_u32 s3, 1
    s_cbranch_scc1 L_norp
    v_mov_b32 v21, 0
    s_cmp_ge_i32 s66, 0
    s_cbranch_scc1 L_norp
    buffer_load_dword v20, v21, s[40:43], s101 offen sc1
L_norp:
    buffer_load_dwordx4 v[128:131], v2, s[28:31], s64 offen nt
    s_add_u32 s64, s64, 4096
    buffer_load_dwordx4 v[132:135], v2, s[28:31], s64 offen nt
    s_add_u32 s64, s64, 4096
    buffer_load_dwordx4 v[136:139], v2, s[28:31], s64 offen nt
    s_add_u32 s64, s64, 4096
    buffer_load_dwordx4 v[140:143], v2, s[28:31], s64 offen nt
    s_add_u32 s64, s64, 4096
    buffer_load_dwordx4 v[144:147], v2, s[28:31], s64 offen nt
    s_add_u32 s64, s64, 4096
    buffer_load_dwordx4 v[148:151], v2, s[28:31], s64 offen nt
    s_add_u32 s64, s64, 4096
    buffer_load_dwordx4 v[152:155], v2, s[28:31], s64 offen nt
    s_add_u32 s64, s64, 4096
    buffer_load_dwordx4 v[156:159], v2, s[28:31], s64 offen nt
    s_add_u32 s64, s64, 4096
    buffer_load_dwordx4 v[160:163], v2, s[28:31], s64 offen nt
    s_add_u32 s64, s64, 4096
    buffer_load_dwordx4 v[164:167], v2, s[28:31], s64 offen nt
    s_add_u32 s64, s64, 4096
    buffer_load_dwordx4 v[168:171], v2, s[28:31], s64 offen nt
    s_add_u32 s64, s64, 4096
    buffer_load_dwordx4 v[172:175], v2, s[28:31], s64 offen nt
    s_add_u32 s64, s64, 4096
    s_cmp_eq_u32 s3, 1
    s_cbranch_scc1 L_poller
L_extras:
    s_setprio 1
    v_mov_b32 v45, 0
    v_mov_b32 v23, 0
    v_mov_b32 v44, 0
    v_mov_b32 v22, 0
    s_mov_b32 s32, s8
    s_mov_b32 s33, s9
    s_mov_b32 s34, 0x4000000
    s_mov_b32 s35, 0x20000
    s_mov_b32 s36, s12
    s_mov_b32 s37, s13
    s_mov_b32 s38, 0x500000
    s_mov_b32 s39, 0x20000
    v_mul_u32_u24 v5, 5120, v3
    v_lshl_add_u32 v5, v4, 4, v5
    s_lshl_b32 s72, s57, 7
    s_lshl_b32 s62, s56, 4
    s_add_u32 s72, s72, s62
    s_mul_i32 s72, s72, 1280
    s_add_u32 s73, s72, 2560
    s_cmp_eq_u32 s3, 3
    s_cbranch_scc1 L_wdown
L_exl:
    buffer_load_dwordx4 v[176:179], v2, s[32:35], s65 offen nt
    s_add_u32 s65, s65, 4096
    buffer_load_dwordx4 v[180:183], v5, s[36:39], s72 offen offset:0
    s_nop 0
    buffer_load_dwordx4 v[184:187], v2, s[32:35], s65 offen nt
    s_add_u32 s65, s65, 4096
    buffer_load_dwordx4 v[188:191], v5, s[36:39], s72 offen offset:256
    s_nop 0
    buffer_load_dwordx4 v[192:195], v2, s[32:35], s65 offen nt
    s_add_u32 s65, s65, 4096
    buffer_load_dwordx4 v[196:199], v2, s[32:35], s65 offen nt
    s_add_u32 s65, s65, 4096
    buffer_load_dwordx4 v[200:203], v5, s[36:39], s72 offen offset:512
    s_nop 0
    buffer_load_dwordx4 v[204:207], v2, s[32:35], s65 offen nt
    s_add_u32 s65, s65, 4096
    buffer_load_dwordx4 v[208:211], v5, s[36:39], s72 offen offset:768
    s_nop 0
    buffer_load_dwordx4 v[212:215], v2, s[32:35], s65 offen nt
    s_add_u32 s65, s65, 4096
    buffer_load_dwordx4 v[216:219], v2, s[32:35], s65 offen nt
    s_add_u32 s65, s65, 4096
    buffer_load_dwordx4 v[220:223], v5, s[36:39], s72 offen offset:1024
    s_nop 0
    s_cmp_eq_u32 s3, 4
    s_cbranch_scc1 L_rest
L_qw:
    v_lshlrev_b32 v36, 4, v4
    s_mov_b32 s80, 0
L_qwait:
    ds_read_b128 v[10:13], v36 offset:0
    ds_read_b32 v40, v45 offset:256
    s_waitcnt lgkmcnt(0)
    v_max3_u32 v37, v10, v11, v12
    v_max_u32 v37, v37, v13
    v_cmp_eq_u32 vcc, -1, v37
    s_cmp_eq_u64 vcc, 0
    s_cbranch_scc1 L_qok
    s_sleep 2
    s_add_u32 s80, s80, 1
    s_cmp_lt_u32 s80, 0x100000
    s_cbranch_scc1 L_qwait
L_qok:
    s_setprio 3
    v_readfirstlane_b32 s15, v40
    s_nop 0
    s_bfe_u32 s16, s15, 0x40000
    s_bfe_u32 s17, s15, 0x40004
    s_bfe_u32 s18, s15, 0x40008
    s_bfe_u32 s19, s15, 0x4000c
    s_mov_b32 s74, 0x3db504f3
    s_mov_b32 s75, 0xffff0000
    s_waitcnt vmcnt(36)
    v_dot2_f32_bf16 v28, v48, v10, 0
    v_dot2_f32_bf16 v29, v52, v10, 0
    v_dot2_f32_bf16 v30, v56, v10, 0
    v_dot2_f32_bf16 v31, v60, v10, 0
    v_dot2_f32_bf16 v32, v64, v10, 0
    v_dot2_f32_bf16 v33, v68, v10, 0
    v_dot2_f32_bf16 v34, v72, v10, 0
    v_dot2_f32_bf16 v35, v76, v10, 0
    v_dot2_f32_bf16 v28, v49, v11, v28
    v_dot2_f32_bf16 v29, v53, v11, v29
    v_dot2_f32_bf16 v30, v57, v11, v30
    v_dot2_f32_bf16 v31, v61, v11, v31
    v_dot2_f32_bf16 v32, v65, v11, v32
    v_dot2_f32_bf16 v33, v69, v11, v33
    v_dot2_f32_bf16 v34, v73, v11, v34
    v_dot2_f32_bf16 v35, v77, v11, v35
    v_dot2_f32_bf16 v28, v50, v12, v28
    v_dot2_f32_bf16 v29, v54, v12, v29
    v_dot2_f32_bf16 v30, v58, v12, v30
    v_dot2_f32_bf16 v31, v62, v12, v31
    v_dot2_f32_bf16 v32, v66, v12, v32
    v_dot2_f32_bf16 v33, v70, v12, v33
    v_dot2_f32_bf16 v34, v74, v12, v34
    v_dot2_f32_bf16 v35, v78, v12, v35
    v_dot2_f32_bf16 v28, v51, v13, v28
    v_dot2_f32_bf16 v29, v55, v13, v29
    v_dot2_f32_bf16 v30, v59, v13, v30
    v_dot2_f32_bf16 v31, v63, v13, v31
    v_dot2_f32_bf16 v32, v67, v13, v32
    v_dot2_f32_bf16 v33, v71, v13, v33
    v_dot2_f32_bf16 v34, v75, v13, v34
    v_dot2_f32_bf16 v35, v79, v13, v35
    v_add_f32_dpp v36, v28, v28 row_ror:8 row_mask:0xf bank_mask:0x3
    v_add_f32_dpp v36, v29, v29 row_ror:8 row_mask:0xf bank_mask:0xc
    v_add_f32_dpp v37, v30, v30 row_ror:8 row_mask:0xf bank_mask:0x3
    v_add_f32_dpp v37, v31, v31 row_ror:8 row_mask:0xf bank_mask:0xc
    v_add_f32_dpp v38, v32, v32 row_ror:8 row_mask:0xf bank_mask:0x3
    v_add_f32_dpp v38, v33, v33 row_ror:8 row_mask:0xf bank_mask:0xc
    v_add_f32_dpp v39, v34, v34 row_ror:8 row_mask:0xf bank_mask:0x3
    v_add_f32_dpp v39, v35, v35 row_ror:8 row_mask:0xf bank_mask:0xc
    v_add_f32_dpp v40, v36, v36 row_shl:4 row_mask:0xf bank_mask:0x5
    v_add_f32_dpp v40, v37, v37 row_shr:4 row_mask:0xf bank_mask:0xa
    v_add_f32_dpp v41, v38, v38 row_shl:4 row_mask:0xf bank_mask:0x5
    v_add_f32_dpp v41, v39, v39 row_shr:4 row_mask:0xf bank_mask:0xa
    s_nop 0
    v_add_f32_dpp v40, v40, v40 quad_perm:[1,0,3,2] row_mask:0xf bank_mask:0xf
    v_add_f32_dpp v41, v41, v41 quad_perm:[1,0,3,2] row_mask:0xf bank_mask:0xf
    s_nop 0
    v_add_f32_dpp v40, v40, v40 quad_perm:[2,3,0,1] row_mask:0xf bank_mask:0xf
    v_add_f32_dpp v41, v41, v41 quad_perm:[2,3,0,1] row_mask:0xf bank_mask:0xf
    s_nop 0
    v_cvt_pk_bf16_f32 v36, v40, v41
    v_lshlrev_b32 v37, 16, v36
    v_and_b32 v38, s75, v36
    v_mul_f32 v37, s74, v37
    v_mul_f32 v38, s74, v38
    v_cvt_pk_bf16_f32 v36, v37, v38
    v_lshlrev_b32 v14, 16, v36
    v_and_b32 v15, s75, v36
    s_waitcnt vmcnt(28)
    v_dot2_f32_bf16 v28, v80, v10, 0
    v_dot2_f32_bf16 v29, v84, v10, 0
    v_dot2_f32_bf16 v30, v88, v10, 0
    v_dot2_f32_bf16 v31, v92, v10, 0
    v_dot2_f32_bf16 v32, v96, v10, 0
    v_dot2_f32_bf16 v33, v100, v10, 0
    v_dot2_f32_bf16 v34, v104, v10, 0
    v_dot2_f32_bf16 v35, v108, v10, 0
    v_dot2_f32_bf16 v28, v81, v11, v28
    v_dot2_f32_bf16 v29, v85, v11, v29
    v_dot2_f32_bf16 v30, v89, v11, v30
    v_dot2_f32_bf16 v31, v93, v11, v31
    v_dot2_f32_bf16 v32, v97, v11, v32
    v_dot2_f32_bf16 v33, v101, v11, v33
    v_dot2_f32_bf16 v34, v105, v11, v34
    v_dot2_f32_bf16 v35, v109, v11, v35
    v_dot2_f32_bf16 v28, v82, v12, v28
    v_dot2_f32_bf16 v29, v86, v12, v29
    v_dot2_f32_bf16 v30, v90, v12, v30
    v_dot2_f32_bf16 v31, v94, v12, v31
    v_dot2_f32_bf16 v32, v98, v12, v32
    v_dot2_f32_bf16 v33, v102, v12, v33
    v_dot2_f32_bf16 v34, v106, v12, v34
    v_dot2_f32_bf16 v35, v110, v12, v35
    v_dot2_f32_bf16 v28, v83, v13, v28
    v_dot2_f32_bf16 v29, v87, v13, v29
    v_dot2_f32_bf16 v30, v91, v13, v30
    v_dot2_f32_bf16 v31, v95, v13, v31
    v_dot2_f32_bf16 v32, v99, v13, v32
    v_dot2_f32_bf16 v33, v103, v13, v33
    v_dot2_f32_bf16 v34, v107, v13, v34
    v_dot2_f32_bf16 v35, v111, v13, v35
    v_add_f32_dpp v36, v28, v28 row_ror:8 row_mask:0xf bank_mask:0x3
    v_add_f32_dpp v36, v29, v29 row_ror:8 row_mask:0xf bank_mask:0xc
    v_add_f32_dpp v37, v30, v30 row_ror:8 row_mask:0xf bank_mask:0x3
    v_add_f32_dpp v37, v31, v31 row_ror:8 row_mask:0xf bank_mask:0xc
    v_add_f32_dpp v38, v32, v32 row_ror:8 row_mask:0xf bank_mask:0x3
    v_add_f32_dpp v38, v33, v33 row_ror:8 row_mask:0xf bank_mask:0xc
    v_add_f32_dpp v39, v34, v34 row_ror:8 row_mask:0xf bank_mask:0x3
    v_add_f32_dpp v39, v35, v35 row_ror:8 row_mask:0xf bank_mask:0xc
    v_add_f32_dpp v40, v36, v36 row_shl:4 row_mask:0xf bank_mask:0x5
    v_add_f32_dpp v40, v37, v37 row_shr:4 row_mask:0xf bank_mask:0xa
    v_add_f32_dpp v41, v38, v38 row_shl:4 row_mask:0xf bank_mask:0x5
    v_add_f32_dpp v41, v39, v39 row_shr:4 row_mask:0xf bank_mask:0xa
    s_nop 0
    v_add_f32_dpp v40, v40, v40 quad_perm:[1,0,3,2] row_mask:0xf bank_mask:0xf
    v_add_f32_dpp v41, v41, v41 quad_perm:[1,0,3,2] row_mask:0xf bank_mask:0xf
    s_nop 0
    v_add_f32_dpp v40, v40, v40 quad_perm:[2,3,0,1] row_mask:0xf bank_mask:0xf
    v_add_f32_dpp v41, v41, v41 quad_perm:[2,3,0,1] row_mask:0xf bank_mask:0xf
    s_nop 0
    v_cvt_pk_bf16_f32 v36, v40, v41
    v_lshlrev_b32 v37, 16, v36
    v_and_b32 v38, s75, v36
    v_mul_f32 v37, s74, v37
    v_mul_f32 v38, s74, v38
    v_cvt_pk_bf16_f32 v36, v37, v38
    v_lshlrev_b32 v16, 16, v36
    v_and_b32 v17, s75, v36
    s_waitcnt vmcnt(20)
    v_dot2_f32_bf16 v28, v112, v10, 0
    v_dot2_f32_bf16 v29, v116, v10, 0
    v_dot2_f32_bf16 v30, v120, v10, 0
    v_dot2_f32_bf16 v31, v124, v10, 0
    v_dot2_f32_bf16 v32, v128, v10, 0
    v_dot2_f32_bf16 v33, v132, v10, 0
    v_dot2_f32_bf16 v34, v136, v10, 0
    v_dot2_f32_bf16 v35, v140, v10, 0
    v_dot2_f32_bf16 v28, v113, v11, v28
    v_dot2_f32_bf16 v29, v117, v11, v29
    v_dot2_f32_bf16 v30, v121, v11, v30
    v_dot2_f32_bf16 v31, v125, v11, v31
    v_dot2_f32_bf16 v32, v129, v11, v32
    v_dot2_f32_bf16 v33, v133, v11, v33
    v_dot2_f32_bf16 v34, v137, v11, v34
    v_dot2_f32_bf16 v35, v141, v11, v35
    v_dot2_f32_bf16 v28, v114, v12, v28
    v_dot2_f32_bf16 v29, v118, v12, v29
    v_dot2_f32_bf16 v30, v122, v12, v30
    v_dot2_f32_bf16 v31, v126, v12, v31
    v_dot2_f32_bf16 v32, v130, v12, v32
    v_dot2_f32_bf16 v33, v134, v12, v33
    v_dot2_f32_bf16 v34, v138, v12, v34
    v_dot2_f32_bf16 v35, v142, v12, v35
    v_dot2_f32_bf16 v28, v115, v13, v28
    v_dot2_f32_bf16 v29, v119, v13, v29
    v_dot2_f32_bf16 v30, v123, v13, v30
    v_dot2_f32_bf16 v31, v127, v13, v31
    v_dot2_f32_bf16 v32, v131, v13, v32
    v_dot2_f32_bf16 v33, v135, v13, v33
    v_dot2_f32_bf16 v34, v139, v13, v34
    v_dot2_f32_bf16 v35, v143, v13, v35
    v_add_f32_dpp v36, v28, v28 row_ror:8 row_mask:0xf bank_mask:0x3
    v_add_f32_dpp v36, v29, v29 row_ror:8 row_mask:0xf bank_mask:0xc
    v_add_f32_dpp v37, v30, v30 row_ror:8 row_mask:0xf bank_mask:0x3
    v_add_f32_dpp v37, v31, v31 row_ror:8 row_mask:0xf bank_mask:0xc
    v_add_f32_dpp v38, v32, v32 row_ror:8 row_mask:0xf bank_mask:0x3
    v_add_f32_dpp v38, v33, v33 row_ror:8 row_mask:0xf bank_mask:0xc
    v_add_f32_dpp v39, v34, v34 row_ror:8 row_mask:0xf bank_mask:0x3
    v_add_f32_dpp v39, v35, v35 row_ror:8 row_mask:0xf bank_mask:0xc
    v_add_f32_dpp v40, v36, v36 row_shl:4 row_mask:0xf bank_mask:0x5
    v_add_f32_dpp v40, v37, v37 row_shr:4 row_mask:0xf bank_mask:0xa
    v_add_f32_dpp v41, v38, v38 row_shl:4 row_mask:0xf bank_mask:0x5
    v_add_f32_dpp v41, v39, v39 row_shr:4 row_mask:0xf bank_mask:0xa
    s_nop 0
    v_add_f32_dpp v40, v40, v40 quad_perm:[1,0,3,2] row_mask:0xf bank_mask:0xf
    v_add_f32_dpp v41, v41, v41 quad_perm:[1,0,3,2] row_mask:0xf bank_mask:0xf
    s_nop 0
    v_add_f32_dpp v40, v40, v40 quad_perm:[2,3,0,1] row_mask:0xf bank_mask:0xf
    v_add_f32_dpp v41, v41, v41 quad_perm:[2,3,0,1] row_mask:0xf bank_mask:0xf
    s_nop 0
    v_cvt_pk_bf16_f32 v36, v40, v41
    v_lshlrev_b32 v37, 16, v36
    v_and_b32 v38, s75, v36
    v_mul_f32 v37, s74, v37
    v_mul_f32 v38, s74, v38
    v_cvt_pk_bf16_f32 v36, v37, v38
    v_lshlrev_b32 v18, 16, v36
    v_and_b32 v19, s75, v36
    s_waitcnt vmcnt(12)
    v_dot2_f32_bf16 v28, v144, v10, 0
    v_dot2_f32_bf16 v29, v148, v10, 0
    v_dot2_f32_bf16 v30, v152, v10, 0
    v_dot2_f32_bf16 v31, v156, v10, 0
    v_dot2_f32_bf16 v32, v160, v10, 0
    v_dot2_f32_bf16 v33, v164, v10, 0
    v_dot2_f32_bf16 v34, v168, v10, 0
    v_dot2_f32_bf16 v35, v172, v10, 0
    v_dot2_f32_bf16 v28, v145, v11, v28
    v_dot2_f32_bf16 v29, v149, v11, v29
    v_dot2_f32_bf16 v30, v153, v11, v30
    v_dot2_f32_bf16 v31, v157, v11, v31
    v_dot2_f32_bf16 v32, v161, v11, v32
    v_dot2_f32_bf16 v33, v165, v11, v33
    v_dot2_f32_bf16 v34, v169, v11, v34
    v_dot2_f32_bf16 v35, v173, v11, v35
    v_dot2_f32_bf16 v28, v146, v12, v28
    v_dot2_f32_bf16 v29, v150, v12, v29
    v_dot2_f32_bf16 v30, v154, v12, v30
    v_dot2_f32_bf16 v31, v158, v12, v31
    v_dot2_f32_bf16 v32, v162, v12, v32
    v_dot2_f32_bf16 v33, v166, v12, v33
    v_dot2_f32_bf16 v34, v170, v12, v34
    v_dot2_f32_bf16 v35, v174, v12, v35
    v_dot2_f32_bf16 v28, v147, v13, v28
    v_dot2_f32_bf16 v29, v151, v13, v29
    v_dot2_f32_bf16 v30, v155, v13, v30
    v_dot2_f32_bf16 v31, v159, v13, v31
    v_dot2_f32_bf16 v32, v163, v13, v32
    v_dot2_f32_bf16 v33, v167, v13, v33
    v_dot2_f32_bf16 v34, v171, v13, v34
    v_dot2_f32_bf16 v35, v175, v13, v35
    v_add_f32_dpp v36, v28, v28 row_ror:8 row_mask:0xf bank_mask:0x3
    v_add_f32_dpp v36, v29, v29 row_ror:8 row_mask:0xf bank_mask:0xc
    v_add_f32_dpp v37, v30, v30 row_ror:8 row_mask:0xf bank_mask:0x3
    v_add_f32_dpp v37, v31, v31 row_ror:8 row_mask:0xf bank_mask:0xc
    v_add_f32_dpp v38, v32, v32 row_ror:8 row_mask:0xf bank_mask:0x3
    v_add_f32_dpp v38, v33, v33 row_ror:8 row_mask:0xf bank_mask:0xc
    v_add_f32_dpp v39, v34, v34 row_ror:8 row_mask:0xf bank_mask:0x3
    v_add_f32_dpp v39, v35, v35 row_ror:8 row_mask:0xf bank_mask:0xc
    v_add_f32_dpp v40, v36, v36 row_shl:4 row_mask:0xf bank_mask:0x5
    v_add_f32_dpp v40, v37, v37 row_shr:4 row_mask:0xf bank_mask:0xa
    v_add_f32_dpp v41, v38, v38 row_shl:4 row_mask:0xf bank_mask:0x5
    v_add_f32_dpp v41, v39, v39 row_shr:4 row_mask:0xf bank_mask:0xa
    s_nop 0
    v_add_f32_dpp v40, v40, v40 quad_perm:[1,0,3,2] row_mask:0xf bank_mask:0xf
    v_add_f32_dpp v41, v41, v41 quad_perm:[1,0,3,2] row_mask:0xf bank_mask:0xf
    s_nop 0
    v_add_f32_dpp v40, v40, v40 quad_perm:[2,3,0,1] row_mask:0xf bank_mask:0xf
    v_add_f32_dpp v41, v41, v41 quad_perm:[2,3,0,1] row_mask:0xf bank_mask:0xf
    s_nop 0
    v_cvt_pk_bf16_f32 v36, v40, v41
    v_lshlrev_b32 v37, 16, v36
    v_and_b32 v38, s75, v36
    v_mul_f32 v37, s74, v37
    v_mul_f32 v38, s74, v38
    v_cvt_pk_bf16_f32 v36, v37, v38
    v_lshlrev_b32 v20, 16, v36
    v_and_b32 v21, s75, v36
    v_max3_f32 v40, v14, v15, v16
    v_max3_f32 v41, v17, v18, v19
    v_max3_f32 v40, v40, v20, v21
    v_max_f32 v40, v40, v41
    s_nop 1
    v_max_f32_dpp v40, v40, v40 row_ror:4 row_mask:0xf bank_mask:0xf
    s_nop 1
    v_max_f32_dpp v40, v40, v40 row_ror:8 row_mask:0xf bank_mask:0xf
    v_mov_b32 v41, v40
    s_nop 1
    v_permlane16_swap_b32 v40, v41
    v_max_f32 v40, v40, v41
    v_mov_b32 v41, v40
    s_nop 1
    v_permlane32_swap_b32 v40, v41
    v_max_f32 v40, v40, v41
    s_mov_b32 s74, 0x3fb8aa3b
    v_mul_f32 v36, s74, v40
    v_fma_f32 v14, v14, s74, -v36
    v_fma_f32 v15, v15, s74, -v36
    v_fma_f32 v16, v16, s74, -v36
    v_fma_f32 v17, v17, s74, -v36
    v_fma_f32 v18, v18, s74, -v36
    v_fma_f32 v19, v19, s74, -v36
    v_fma_f32 v20, v20, s74, -v36
    v_fma_f32 v21, v21, s74, -v36
    v_exp_f32 v14, v14
    v_exp_f32 v15, v15
    v_exp_f32 v16, v16
    v_exp_f32 v17, v17
    v_exp_f32 v18, v18
    v_exp_f32 v19, v19
    v_exp_f32 v20, v20
    v_exp_f32 v21, v21
    v_mov_b32 v38, s15
    v_add_f32 v37, v14, v15
    v_add_f32 v40, v16, v17
    v_add_f32 v37, v37, v18
    v_add_f32 v40, v40, v19
    v_add_f32 v37, v37, v20
    v_add_f32 v40, v40, v21
    v_add_f32 v37, v37, v40
    v_cvt_pk_bf16_f32 v14, v14, v14
    v_cvt_pk_bf16_f32 v15, v15, v15
    v_cvt_pk_bf16_f32 v16, v16, v16
    v_cvt_pk_bf16_f32 v17, v17, v17
    v_cvt_pk_bf16_f32 v18, v18, v18
    v_cvt_pk_bf16_f32 v19, v19, v19
    v_cvt_pk_bf16_f32 v20, v20, v20
    v_cvt_pk_bf16_f32 v21, v21, v21
    v_add_f32_dpp v37, v37, v37 row_ror:4 row_mask:0xf bank_mask:0xf
    s_nop 1
    v_add_f32_dpp v37, v37, v37 row_ror:8 row_mask:0xf bank_mask:0xf
    v_mov_b32 v41, v37
    s_nop 1
    v_permlane16_swap_b32 v37, v41
    v_add_f32 v37, v37, v41
    v_mov_b32 v41, v37
    s_nop 1
    v_permlane32_swap_b32 v37, v41
    v_add_f32 v37, v37, v41
    v_mov_b32 v39, s15
    s_lshl_b32 s61, s56, 3
    v_mov_b32 v40, s61
    v_mov_b32 v41, 1
    s_mov_b64 exec, 1
    ds_write_b64 v40, v[36:37] offset:33792
    ds_add_rtn_u32 v41, v45, v41 offset:33856
    s_mov_b64 exec, -1
    v_and_b32 v40, 7, v1
    v_lshlrev_b32 v40, 3, v40
    s_waitcnt lgkmcnt(0)
    v_readfirstlane_b32 s61, v41
    s_nop 0
    s_cmp_lg_u32 s61, 7
    s_cbranch_scc1 L_nost
    ds_read_b64 v[42:43], v40 offset:33792
    s_lshl_b32 s61, s59, 4
    s_mul_i32 s62, s81, 32256
    s_add_u32 s61, s61, s62
    s_add_u32 s61, s61, 4096
    s_waitcnt lgkmcnt(0)
    v_mov_b32 v36, v42
    s_nop 1
    v_max_f32_dpp v36, v36, v36 quad_perm:[1,0,3,2] row_mask:0xf bank_mask:0xf
    s_nop 1
    v_max_f32_dpp v36, v36, v36 quad_perm:[2,3,0,1] row_mask:0xf bank_mask:0xf
    s_nop 1
    v_max_f32_dpp v36, v36, v36 row_half_mirror row_mask:0xf bank_mask:0xf
    v_sub_f32 v37, v42, v36
    v_exp_f32 v37, v37
    s_nop 0
    v_mul_f32 v37, v37, v43
    s_nop 1
    v_add_f32_dpp v37, v37, v37 quad_perm:[1,0,3,2] row_mask:0xf bank_mask:0xf
    s_nop 1
    v_add_f32_dpp v37, v37, v37 quad_perm:[2,3,0,1] row_mask:0xf bank_mask:0xf
    s_nop 1
    v_add_f32_dpp v37, v37, v37 row_half_mirror row_mask:0xf bank_mask:0xf
    s_mov_b64 exec, 1
    buffer_store_dwordx4 v[36:39], v45, s[40:43], s61 offen sc1
    s_mov_b64 exec, -1
L_nost:
    s_cmp_eq_u32 s3, 3
    s_cbranch_scc1 L_ffn2
L_rest:
    s_setprio 0
    buffer_load_dwordx4 v[224:227], v2, s[32:35], s65 offen nt
    s_add_u32 s65, s65, 4096
    buffer_load_dwordx4 v[228:231], v2, s[32:35], s65 offen nt
    s_add_u32 s65, s65, 4096
    buffer_load_dwordx4 v[232:235], v5, s[36:39], s72 offen offset:1280
    s_nop 0
    buffer_load_dwordx4 v[236:239], v2, s[32:35], s65 offen nt
    s_add_u32 s65, s65, 4096
    buffer_load_dwordx4 v[240:243], v5, s[36:39], s72 offen offset:1536
    s_nop 0
    buffer_load_dwordx4 v[244:247], v2, s[32:35], s65 offen nt
    s_add_u32 s65, s65, 4096
    buffer_load_dwordx4 v[248:251], v2, s[32:35], s65 offen nt
    s_add_u32 s65, s65, 4096
    buffer_load_dwordx4 v[252:255], v5, s[36:39], s72 offen offset:1792
    s_nop 0
    buffer_load_dwordx4 v[48:51], v2, s[32:35], s65 offen nt
    s_add_u32 s65, s65, 4096
    buffer_load_dwordx4 v[52:55], v5, s[36:39], s72 offen offset:2048
    s_nop 0
    buffer_load_dwordx4 v[56:59], v2, s[32:35], s65 offen nt
    s_add_u32 s65, s65, 4096
    buffer_load_dwordx4 v[60:63], v2, s[32:35], s65 offen nt
    s_add_u32 s65, s65, 4096
    buffer_load_dwordx4 v[64:67], v5, s[36:39], s72 offen offset:2304
    s_nop 0
    buffer_load_dwordx4 v[68:71], v2, s[32:35], s65 offen nt
    s_add_u32 s65, s65, 4096
    buffer_load_dwordx4 v[72:75], v2, s[32:35], s65 offen nt
    s_add_u32 s65, s65, 4096
    buffer_load_dwordx4 v[76:79], v5, s[36:39], s73 offen offset:0
    s_nop 0
    buffer_load_dwordx4 v[80:83], v2, s[32:35], s65 offen nt
    s_add_u32 s65, s65, 4096
    buffer_load_dwordx4 v[84:87], v5, s[36:39], s73 offen offset:256
    s_nop 0
    buffer_load_dwordx4 v[88:91], v2, s[32:35], s65 offen nt
    s_add_u32 s65, s65, 4096
    buffer_load_dwordx4 v[92:95], v2, s[32:35], s65 offen nt
    s_add_u32 s65, s65, 4096
    buffer_load_dwordx4 v[96:99], v5, s[36:39], s73 offen offset:512
    s_nop 0
    buffer_load_dwordx4 v[100:103], v2, s[32:35], s65 offen nt
    s_add_u32 s65, s65, 4096
    buffer_load_dwordx4 v[104:107], v5, s[36:39], s73 offen offset:768
    s_nop 0
    buffer_load_dwordx4 v[108:111], v2, s[32:35], s65 offen nt
    s_add_u32 s65, s65, 4096
    buffer_load_dwordx4 v[112:115], v2, s[32:35], s65 offen nt
    s_add_u32 s65, s65, 4096
    buffer_load_dwordx4 v[116:119], v5, s[36:39], s73 offen offset:1024
    s_nop 0
    buffer_load_dwordx4 v[120:123], v2, s[32:35], s65 offen nt
    s_add_u32 s65, s65, 4096
    buffer_load_dwordx4 v[124:127], v2, s[32:35], s65 offen nt
    s_add_u32 s65, s65, 4096
    buffer_load_dwordx4 v[128:131], v5, s[36:39], s73 offen offset:1280
    s_nop 0
    buffer_load_dwordx4 v[132:135], v2, s[32:35], s65 offen nt
    s_add_u32 s65, s65, 4096
    buffer_load_dwordx4 v[136:139], v5, s[36:39], s73 offen offset:1536
    s_nop 0
    buffer_load_dwordx4 v[140:143], v2, s[32:35], s65 offen nt
    s_add_u32 s65, s65, 4096
    buffer_load_dwordx4 v[144:147], v2, s[32:35], s65 offen nt
    s_add_u32 s65, s65, 4096
    buffer_load_dwordx4 v[148:151], v5, s[36:39], s73 offen offset:1792
    s_nop 0
    buffer_load_dwordx4 v[152:155], v2, s[32:35], s65 offen nt
    s_add_u32 s65, s65, 4096
    buffer_load_dwordx4 v[156:159], v5, s[36:39], s73 offen offset:2048
    s_nop 0
    buffer_load_dwordx4 v[160:163], v2, s[32:35], s65 offen nt
    s_add_u32 s65, s65, 4096
    buffer_load_dwordx4 v[164:167], v2, s[32:35], s65 offen nt
    s_add_u32 s65, s65, 4096
    buffer_load_dwordx4 v[168:171], v5, s[36:39], s73 offen offset:2304
    s_nop 0
    buffer_load_dwordx4 v[172:175], v2, s[32:35], s65 offen nt
    s_add_u32 s65, s65, 4096
    v_lshlrev_b32 v36, 5, v4
    v_lshl_add_u32 v36, v3, 4, v36
    s_mul_i32 s61, s56, 544
    v_add_u32 v41, s61, v36
    v_and_b32 v37, 0x1f0, v2
    s_mul_i32 s61, s56, 2560
    v_add_u32 v42, s61, v37
    v_and_b32 v36, 7, v1
    v_mul_u32_u24 v40, 544, v36
    v_lshl_add_u32 v40, v3, 4, v40
    s_lshl_b32 s61, s56, 6
    v_add_u32 v40, s61, v40
    v_lshlrev_b32 v43, 2, v36
    s_mul_i32 s76, s59, 2560
    s_mul_i32 s62, s81, 32256
    s_add_u32 s76, s76, s62
    s_add_u32 s76, s76, 10240
    s_cmp_eq_u32 s3, 5
    s_cbranch_scc1 L_c1
    s_cmp_eq_u32 s3, 2
    s_cbranch_scc1 L_s1
L_vphase:
    v_and_b32_dpp v28, v14, v6 row_newbcast:0 row_mask:0xf bank_mask:0xf
    v_and_b32_dpp v29, v14, v7 row_newbcast:0 row_mask:0xf bank_mask:0xf
    v_and_b32_dpp v30, v14, v8 row_newbcast:0 row_mask:0xf bank_mask:0xf
    v_and_b32_dpp v31, v14, v9 row_newbcast:0 row_mask:0xf bank_mask:0xf
    v_and_b32_dpp v32, v14, v6 row_newbcast:8 row_mask:0xf bank_mask:0xf
    v_and_b32_dpp v33, v14, v7 row_newbcast:8 row_mask:0xf bank_mask:0xf
    v_and_b32_dpp v34, v14, v8 row_newbcast:8 row_mask:0xf bank_mask:0xf
    v_and_b32_dpp v35, v14, v9 row_newbcast:8 row_mask:0xf bank_mask:0xf
    s_waitcnt vmcnt(51)
    v_mfma_f32_16x16x32_bf16 v[24:27], v[28:31], v[176:179], 0
    v_and_b32_dpp v28, v14, v6 row_newbcast:4 row_mask:0xf bank_mask:0xf
    v_and_b32_dpp v29, v14, v7 row_newbcast:4 row_mask:0xf bank_mask:0xf
    v_and_b32_dpp v30, v14, v8 row_newbcast:4 row_mask:0xf bank_mask:0xf
    v_and_b32_dpp v31, v14, v9 row_newbcast:4 row_mask:0xf bank_mask:0xf
    s_waitcnt vmcnt(49)
    v_mfma_f32_16x16x32_bf16 v[24:27], v[32:35], v[184:187], v[24:27]
    v_and_b32_dpp v32, v14, v6 row_newbcast:12 row_mask:0xf bank_mask:0xf
    v_and_b32_dpp v33, v14, v7 row_newbcast:12 row_mask:0xf bank_mask:0xf
    v_and_b32_dpp v34, v14, v8 row_newbcast:12 row_mask:0xf bank_mask:0xf
    v_and_b32_dpp v35, v14, v9 row_newbcast:12 row_mask:0xf bank_mask:0xf
    s_waitcnt vmcnt(47)
    v_mfma_f32_16x16x32_bf16 v[24:27], v[28:31], v[192:195], v[24:27]
    v_and_b32_dpp v28, v15, v6 row_newbcast:0 row_mask:0xf bank_mask:0xf
    v_and_b32_dpp v29, v15, v7 row_newbcast:0 row_mask:0xf bank_mask:0xf
    v_and_b32_dpp v30, v15, v8 row_newbcast:0 row_mask:0xf bank_mask:0xf
    v_and_b32_dpp v31, v15, v9 row_newbcast:0 row_mask:0xf bank_mask:0xf
    s_waitcnt vmcnt(46)
    v_mfma_f32_16x16x32_bf16 v[24:27], v[32:35], v[196:199], v[24:27]
    v_and_b32_dpp v32, v15, v6 row_newbcast:8 row_mask:0xf bank_mask:0xf
    v_and_b32_dpp v33, v15, v7 row_newbcast:8 row_mask:0xf bank_mask:0xf
    v_and_b32_dpp v34, v15, v8 row_newbcast:8 row_mask:0xf bank_mask:0xf
    v_and_b32_dpp v35, v15, v9 row_newbcast:8 row_mask:0xf bank_mask:0xf
    s_waitcnt vmcnt(44)
    v_mfma_f32_16x16x32_bf16 v[24:27], v[28:31], v[204:207], v[24:27]
    v_and_b32_dpp v28, v15, v6 row_newbcast:4 row_mask:0xf bank_mask:0xf
    v_and_b32_dpp v29, v15, v7 row_newbcast:4 row_mask:0xf bank_mask:0xf
    v_and_b32_dpp v30, v15, v8 row_newbcast:4 row_mask:0xf bank_mask:0xf
    v_and_b32_dpp v31, v15, v9 row_newbcast:4 row_mask:0xf bank_mask:0xf
    s_waitcnt vmcnt(42)
    v_mfma_f32_16x16x32_bf16 v[24:27], v[32:35], v[212:215], v[24:27]
    v_and_b32_dpp v32, v15, v6 row_newbcast:12 row_mask:0xf bank_mask:0xf
    v_and_b32_dpp v33, v15, v7 row_newbcast:12 row_mask:0xf bank_mask:0xf
    v_and_b32_dpp v34, v15, v8 row_newbcast:12 row_mask:0xf bank_mask:0xf
    v_and_b32_dpp v35, v15, v9 row_newbcast:12 row_mask:0xf bank_mask:0xf
    s_waitcnt vmcnt(41)
    v_mfma_f32_16x16x32_bf16 v[24:27], v[28:31], v[216:219], v[24:27]
    v_and_b32_dpp v28, v16, v6 row_newbcast:0 row_mask:0xf bank_mask:0xf
    v_and_b32_dpp v29, v16, v7 row_newbcast:0 row_mask:0xf bank_mask:0xf
    v_and_b32_dpp v30, v16, v8 row_newbcast:0 row_mask:0xf bank_mask:0xf
    v_and_b32_dpp v31, v16, v9 row_newbcast:0 row_mask:0xf bank_mask:0xf
    s_waitcnt vmcnt(39)
    v_mfma_f32_16x16x32_bf16 v[24:27], v[32:35], v[224:227], v[24:27]
    v_and_b32_dpp v32, v16, v6 row_newbcast:8 row_mask:0xf bank_mask:0xf
    v_and_b32_dpp v33, v16, v7 row_newbcast:8 row_mask:0xf bank_mask:0xf
    v_and_b32_dpp v34, v16, v8 row_newbcast:8 row_mask:0xf bank_mask:0xf
    v_and_b32_dpp v35, v16, v9 row_newbcast:8 row_mask:0xf bank_mask:0xf
    s_waitcnt vmcnt(38)
    v_mfma_f32_16x16x32_bf16 v[24:27], v[28:31], v[228:231], v[24:27]
    v_and_b32_dpp v28, v16, v6 row_newbcast:4 row_mask:0xf bank_mask:0xf
    v_and_b32_dpp v29, v16, v7 row_newbcast:4 row_mask:0xf bank_mask:0xf
    v_and_b32_dpp v30, v16, v8 row_newbcast:4 row_mask:0xf bank_mask:0xf
    v_and_b32_dpp v31, v16, v9 row_newbcast:4 row_mask:0xf bank_mask:0xf
    s_waitcnt vmcnt(36)
    v_mfma_f32_16x16x32_bf16 v[24:27], v[32:35], v[236:239], v[24:27]
    v_and_b32_dpp v32, v16, v6 row_newbcast:12 row_mask:0xf bank_mask:0xf
    v_and_b32_dpp v33, v16, v7 row_newbcast:12 row_mask:0xf bank_mask:0xf
    v_and_b32_dpp v34, v16, v8 row_newbcast:12 row_mask:0xf bank_mask:0xf
    v_and_b32_dpp v35, v16, v9 row_newbcast:12 row_mask:0xf bank_mask:0xf
    s_waitcnt vmcnt(34)
    v_mfma_f32_16x16x32_bf16 v[24:27], v[28:31], v[244:247], v[24:27]
    v_and_b32_dpp v28, v17, v6 row_newbcast:0 row_mask:0xf bank_mask:0xf
    v_and_b32_dpp v29, v17, v7 row_newbcast:0 row_mask:0xf bank_mask:0xf
    v_and_b32_dpp v30, v17, v8 row_newbcast:0 row_mask:0xf bank_mask:0xf
    v_and_b32_dpp v31, v17, v9 row_newbcast:0 row_mask:0xf bank_mask:0xf
    s_waitcnt vmcnt(33)
    v_mfma_f32_16x16x32_bf16 v[24:27], v[32:35], v[248:251], v[24:27]
    v_and_b32_dpp v32, v17, v6 row_newbcast:8 row_mask:0xf bank_mask:0xf
    v_and_b32_dpp v33, v17, v7 row_newbcast:8 row_mask:0xf bank_mask:0xf
    v_and_b32_dpp v34, v17, v8 row_newbcast:8 row_mask:0xf bank_mask:0xf
    v_and_b32_dpp v35, v17, v9 row_newbcast:8 row_mask:0xf bank_mask:0xf
    s_waitcnt vmcnt(31)
    v_mfma_f32_16x16x32_bf16 v[24:27], v[28:31], v[48:51], v[24:27]
    v_and_b32_dpp v28, v17, v6 row_newbcast:4 row_mask:0xf bank_mask:0xf
    v_and_b32_dpp v29, v17, v7 row_newbcast:4 row_mask:0xf bank_mask:0xf
    v_and_b32_dpp v30, v17, v8 row_newbcast:4 row_mask:0xf bank_mask:0xf
    v_and_b32_dpp v31, v17, v9 row_newbcast:4 row_mask:0xf bank_mask:0xf
    s_waitcnt vmcnt(29)
    v_mfma_f32_16x16x32_bf16 v[24:27], v[32:35], v[56:59], v[24:27]
    v_and_b32_dpp v32, v17, v6 row_newbcast:12 row_mask:0xf bank_mask:0xf
    v_and_b32_dpp v33, v17, v7 row_newbcast:12 row_mask:0xf bank_mask:0xf
    v_and_b32_dpp v34, v17, v8 row_newbcast:12 row_mask:0xf bank_mask:0xf
    v_and_b32_dpp v35, v17, v9 row_newbcast:12 row_mask:0xf bank_mask:0xf
    s_waitcnt vmcnt(28)
    v_mfma_f32_16x16x32_bf16 v[24:27], v[28:31], v[60:63], v[24:27]
    v_and_b32_dpp v28, v18, v6 row_newbcast:0 row_mask:0xf bank_mask:0xf
    v_and_b32_dpp v29, v18, v7 row_newbcast:0 row_mask:0xf bank_mask:0xf
    v_and_b32_dpp v30, v18, v8 row_newbcast:0 row_mask:0xf bank_mask:0xf
    v_and_b32_dpp v31, v18, v9 row_newbcast:0 row_mask:0xf bank_mask:0xf
    s_waitcnt vmcnt(26)
    v_mfma_f32_16x16x32_bf16 v[24:27], v[32:35], v[68:71], v[24:27]
    v_and_b32_dpp v32, v18, v6 row_newbcast:8 row_mask:0xf bank_mask:0xf
    v_and_b32_dpp v33, v18, v7 row_newbcast:8 row_mask:0xf bank_mask:0xf
    v_and_b32_dpp v34, v18, v8 row_newbcast:8 row_mask:0xf bank_mask:0xf
    v_and_b32_dpp v35, v18, v9 row_newbcast:8 row_mask:0xf bank_mask:0xf
    s_waitcnt vmcnt(25)
    v_mfma_f32_16x16x32_bf16 v[24:27], v[28:31], v[72:75], v[24:27]
    v_and_b32_dpp v28, v18, v6 row_newbcast:4 row_mask:0xf bank_mask:0xf
    v_and_b32_dpp v29, v18, v7 row_newbcast:4 row_mask:0xf bank_mask:0xf
    v_and_b32_dpp v30, v18, v8 row_newbcast:4 row_mask:0xf bank_mask:0xf
    v_and_b32_dpp v31, v18, v9 row_newbcast:4 row_mask:0xf bank_mask:0xf
    s_waitcnt vmcnt(23)
    v_mfma_f32_16x16x32_bf16 v[24:27], v[32:35], v[80:83], v[24:27]
    v_and_b32_dpp v32, v18, v6 row_newbcast:12 row_mask:0xf bank_mask:0xf
    v_and_b32_dpp v33, v18, v7 row_newbcast:12 row_mask:0xf bank_mask:0xf
    v_and_b32_dpp v34, v18, v8 row_newbcast:12 row_mask:0xf bank_mask:0xf
    v_and_b32_dpp v35, v18, v9 row_newbcast:12 row_mask:0xf bank_mask:0xf
    s_waitcnt vmcnt(21)
    v_mfma_f32_16x16x32_bf16 v[24:27], v[28:31], v[88:91], v[24:27]
    v_and_b32_dpp v28, v19, v6 row_newbcast:0 row_mask:0xf bank_mask:0xf
    v_and_b32_dpp v29, v19, v7 row_newbcast:0 row_mask:0xf bank_mask:0xf
    v_and_b32_dpp v30, v19, v8 row_newbcast:0 row_mask:0xf bank_mask:0xf
    v_and_b32_dpp v31, v19, v9 row_newbcast:0 row_mask:0xf bank_mask:0xf
    s_waitcnt vmcnt(20)
    v_mfma_f32_16x16x32_bf16 v[24:27], v[32:35], v[92:95], v[24:27]
    v_and_b32_dpp v32, v19, v6 row_newbcast:8 row_mask:0xf bank_mask:0xf
    v_and_b32_dpp v33, v19, v7 row_newbcast:8 row_mask:0xf bank_mask:0xf
    v_and_b32_dpp v34, v19, v8 row_newbcast:8 row_mask:0xf bank_mask:0xf
    v_and_b32_dpp v35, v19, v9 row_newbcast:8 row_mask:0xf bank_mask:0xf
    s_waitcnt vmcnt(18)
    v_mfma_f32_16x16x32_bf16 v[24:27], v[28:31], v[100:103], v[24:27]
    v_and_b32_dpp v28, v19, v6 row_newbcast:4 row_mask:0xf bank_mask:0xf
    v_and_b32_dpp v29, v19, v7 row_newbcast:4 row_mask:0xf bank_mask:0xf
    v_and_b32_dpp v30, v19, v8 row_newbcast:4 row_mask:0xf bank_mask:0xf
    v_and_b32_dpp v31, v19, v9 row_newbcast:4 row_mask:0xf bank_mask:0xf
    s_waitcnt vmcnt(16)
    v_mfma_f32_16x16x32_bf16 v[24:27], v[32:35], v[108:111], v[24:27]
    v_and_b32_dpp v32, v19, v6 row_newbcast:12 row_mask:0xf bank_mask:0xf
    v_and_b32_dpp v33, v19, v7 row_newbcast:12 row_mask:0xf bank_mask:0xf
    v_and_b32_dpp v34, v19, v8 row_newbcast:12 row_mask:0xf bank_mask:0xf
    v_and_b32_dpp v35, v19, v9 row_newbcast:12 row_mask:0xf bank_mask:0xf
    s_waitcnt vmcnt(15)
    v_mfma_f32_16x16x32_bf16 v[24:27], v[28:31], v[112:115], v[24:27]
    v_and_b32_dpp v28, v20, v6 row_newbcast:0 row_mask:0xf bank_mask:0xf
    v_and_b32_dpp v29, v20, v7 row_newbcast:0 row_mask:0xf bank_mask:0xf
    v_and_b32_dpp v30, v20, v8 row_newbcast:0 row_mask:0xf bank_mask:0xf
    v_and_b32_dpp v31, v20, v9 row_newbcast:0 row_mask:0xf bank_mask:0xf
    s_waitcnt vmcnt(13)
    v_mfma_f32_16x16x32_bf16 v[24:27], v[32:35], v[120:123], v[24:27]
    v_and_b32_dpp v32, v20, v6 row_newbcast:8 row_mask:0xf bank_mask:0xf
    v_and_b32_dpp v33, v20, v7 row_newbcast:8 row_mask:0xf bank_mask:0xf
    v_and_b32_dpp v34, v20, v8 row_newbcast:8 row_mask:0xf bank_mask:0xf
    v_and_b32_dpp v35, v20, v9 row_newbcast:8 row_mask:0xf bank_mask:0xf
    s_waitcnt vmcnt(12)
    v_mfma_f32_16x16x32_bf16 v[24:27], v[28:31], v[124:127], v[24:27]
    v_and_b32_dpp v28, v20, v6 row_newbcast:4 row_mask:0xf bank_mask:0xf
    v_and_b32_dpp v29, v20, v7 row_newbcast:4 row_mask:0xf bank_mask:0xf
    v_and_b32_dpp v30, v20, v8 row_newbcast:4 row_mask:0xf bank_mask:0xf
    v_and_b32_dpp v31, v20, v9 row_newbcast:4 row_mask:0xf bank_mask:0xf
    s_waitcnt vmcnt(10)
    v_mfma_f32_16x16x32_bf16 v[24:27], v[32:35], v[132:135], v[24:27]
    v_and_b32_dpp v32, v20, v6 row_newbcast:12 row_mask:0xf bank_mask:0xf
    v_and_b32_dpp v33, v20, v7 row_newbcast:12 row_mask:0xf bank_mask:0xf
    v_and_b32_dpp v34, v20, v8 row_newbcast:12 row_mask:0xf bank_mask:0xf
    v_and_b32_dpp v35, v20, v9 row_newbcast:12 row_mask:0xf bank_mask:0xf
    s_waitcnt vmcnt(8)
    v_mfma_f32_16x16x32_bf16 v[24:27], v[28:31], v[140:143], v[24:27]
    v_and_b32_dpp v28, v21, v6 row_newbcast:0 row_mask:0xf bank_mask:0xf
    v_and_b32_dpp v29, v21, v7 row_newbcast:0 row_mask:0xf bank_mask:0xf
    v_and_b32_dpp v30, v21, v8 row_newbcast:0 row_mask:0xf bank_mask:0xf
    v_and_b32_dpp v31, v21, v9 row_newbcast:0 row_mask:0xf bank_mask:0xf
    s_waitcnt vmcnt(7)
    v_mfma_f32_16x16x32_bf16 v[24:27], v[32:35], v[144:147], v[24:27]
    v_and_b32_dpp v32, v21, v6 row_newbcast:8 row_mask:0xf bank_mask:0xf
    v_and_b32_dpp v33, v21, v7 row_newbcast:8 row_mask:0xf bank_mask:0xf
    v_and_b32_dpp v34, v21, v8 row_newbcast:8 row_mask:0xf bank_mask:0xf
    v_and_b32_dpp v35, v21, v9 row_newbcast:8 row_mask:0xf bank_mask:0xf
    s_waitcnt vmcnt(5)
    v_mfma_f32_16x16x32_bf16 v[24:27], v[28:31], v[152:155], v[24:27]
    v_and_b32_dpp v28, v21, v6 row_newbcast:4 row_mask:0xf bank_mask:0xf
    v_and_b32_dpp v29, v21, v7 row_newbcast:4 row_mask:0xf bank_mask:0xf
    v_and_b32_dpp v30, v21, v8 row_newbcast:4 row_mask:0xf bank_mask:0xf
    v_and_b32_dpp v31, v21, v9 row_newbcast:4 row_mask:0xf bank_mask:0xf
    s_waitcnt vmcnt(3)
    v_mfma_f32_16x16x32_bf16 v[24:27], v[32:35], v[160:163], v[24:27]
    v_and_b32_dpp v32, v21, v6 row_newbcast:12 row_mask:0xf bank_mask:0xf
    v_and_b32_dpp v33, v21, v7 row_newbcast:12 row_mask:0xf bank_mask:0xf
    v_and_b32_dpp v34, v21, v8 row_newbcast:12 row_mask:0xf bank_mask:0xf
    v_and_b32_dpp v35, v21, v9 row_newbcast:12 row_mask:0xf bank_mask:0xf
    s_waitcnt vmcnt(2)
    v_mfma_f32_16x16x32_bf16 v[24:27], v[28:31], v[164:167], v[24:27]
    s_waitcnt vmcnt(0)
    v_mfma_f32_16x16x32_bf16 v[24:27], v[32:35], v[172:175], v[24:27]
    s_mov_b64 exec, 0xffffffff
    s_nop 6
    ds_write_b128 v41, v[24:27] offset:512
    s_mov_b64 exec, -1
    s_cmp_eq_u32 s3, 2
    s_cbranch_scc1 L_w2stats
    s_cmp_eq_u32 s3, 5
    s_cbranch_scc1 L_w3pre
L_bar2:
    v_lshlrev_b32 v34, 4, v0
    v_mov_b32 v33, s15
    v_lshlrev_b32 v32, 24, v1
    s_lshl_b32 s74, s59, 7
    s_mul_i32 s62, s81, 32256
    s_add_u32 s74, s74, s62
    s_add_u32 s74, s74, 4608
    s_waitcnt vmcnt(0)
    s_waitcnt lgkmcnt(0)
    s_barrier
    ds_read_b128 v[36:39], v40 offset:512
    ds_read_b32 v44, v43 offset:320
    s_waitcnt lgkmcnt(0)
    v_mul_f32 v36, v44, v36
    v_mul_f32 v37, v44, v37
    v_mul_f32 v38, v44, v38
    v_mul_f32 v39, v44, v39
    v_add_f32_dpp v36, v36, v36 quad_perm:[1,0,3,2] row_mask:0xf bank_mask:0xf
    v_add_f32_dpp v37, v37, v37 quad_perm:[1,0,3,2] row_mask:0xf bank_mask:0xf
    v_add_f32_dpp v38, v38, v38 quad_perm:[1,0,3,2] row_mask:0xf bank_mask:0xf
    v_add_f32_dpp v39, v39, v39 quad_perm:[1,0,3,2] row_mask:0xf bank_mask:0xf
    v_add_f32_dpp v36, v36, v36 quad_perm:[2,3,0,1] row_mask:0xf bank_mask:0xf
    v_add_f32_dpp v37, v37, v37 quad_perm:[2,3,0,1] row_mask:0xf bank_mask:0xf
    v_add_f32_dpp v38, v38, v38 quad_perm:[2,3,0,1] row_mask:0xf bank_mask:0xf
    v_add_f32_dpp v39, v39, v39 quad_perm:[2,3,0,1] row_mask:0xf bank_mask:0xf
    v_add_f32_dpp v36, v36, v36 row_half_mirror row_mask:0xf bank_mask:0xf
    v_add_f32_dpp v37, v37, v37 row_half_mirror row_mask:0xf bank_mask:0xf
    v_add_f32_dpp v38, v38, v38 row_half_mirror row_mask:0xf bank_mask:0xf
    v_add_f32_dpp v39, v39, v39 row_half_mirror row_mask:0xf bank_mask:0xf
    v_cvt_pk_bf16_f32 v36, v36, v36
    v_cvt_pk_bf16_f32 v37, v37, v37
    v_cvt_pk_bf16_f32 v38, v38, v38
    v_cvt_pk_bf16_f32 v39, v39, v39
    v_and_b32 v80, v36, v6
    v_and_b32 v81, v36, v7
    v_and_b32 v82, v36, v8
    v_and_b32 v83, v36, v9
    v_and_b32 v88, v37, v6
    v_and_b32 v89, v37, v7
    v_mfma_f32_16x16x32_bf16 v[48:51], v[80:83], v[180:183], 0
    v_and_b32 v90, v37, v8
    v_and_b32 v91, v37, v9
    v_and_b32 v92, v38, v6
    v_mfma_f32_16x16x32_bf16 v[56:59], v[80:83], v[188:191], 0
    v_and_b32 v93, v38, v7
    v_and_b32 v94, v38, v8
    v_and_b32 v95, v38, v9
    v_mfma_f32_16x16x32_bf16 v[60:63], v[80:83], v[200:203], 0
    v_and_b32 v100, v39, v6
    v_and_b32 v101, v39, v7
    v_mfma_f32_16x16x32_bf16 v[68:71], v[80:83], v[208:211], 0
    v_and_b32 v102, v39, v8
    v_and_b32 v103, v39, v9
    v_mfma_f32_16x16x32_bf16 v[72:75], v[80:83], v[220:223], 0
    s_nop 0
    v_mfma_f32_16x16x32_bf16 v[48:51], v[88:91], v[232:235], v[48:51]
    v_mfma_f32_16x16x32_bf16 v[48:51], v[92:95], v[76:79], v[48:51]
    v_mfma_f32_16x16x32_bf16 v[48:51], v[100:103], v[128:131], v[48:51]
    s_nop 1
    s_cmp_lg_u32 s56, 7
    s_cbranch_scc1 L_nofl
    buffer_store_dword v33, v32, s[40:43], s74 offen sc1
L_nofl:
    v_mfma_f32_16x16x32_bf16 v[56:59], v[88:91], v[240:243], v[56:59]
    v_mfma_f32_16x16x32_bf16 v[56:59], v[92:95], v[84:87], v[56:59]
    v_mfma_f32_16x16x32_bf16 v[56:59], v[100:103], v[136:139], v[56:59]
    s_nop 1
    v_mfma_f32_16x16x32_bf16 v[60:63], v[88:91], v[252:255], v[60:63]
    v_mfma_f32_16x16x32_bf16 v[60:63], v[92:95], v[96:99], v[60:63]
    v_mfma_f32_16x16x32_bf16 v[60:63], v[100:103], v[148:151], v[60:63]
    ds_write_b128 v42, v[48:51] offset:4864
    s_nop 0
    v_mfma_f32_16x16x32_bf16 v[68:71], v[88:91], v[52:55], v[68:71]
    v_mfma_f32_16x16x32_bf16 v[68:71], v[92:95], v[104:107], v[68:71]
    v_mfma_f32_16x16x32_bf16 v[68:71], v[100:103], v[156:159], v[68:71]
    ds_write_b128 v42, v[56:59] offset:5376
    s_nop 0
    v_mfma_f32_16x16x32_bf16 v[72:75], v[88:91], v[64:67], v[72:75]
    v_mfma_f32_16x16x32_bf16 v[72:75], v[92:95], v[116:119], v[72:75]
    v_mfma_f32_16x16x32_bf16 v[72:75], v[100:103], v[168:171], v[72:75]
    ds_write_b128 v42, v[60:63] offset:5888
    s_nop 0
    s_nop 0
    ds_write_b128 v42, v[68:71] offset:6400
    s_nop 3
    ds_write_b128 v42, v[72:75] offset:6912
    s_waitcnt lgkmcnt(0)
    s_barrier
    s_cmp_ge_u32 s56, 3
    s_cbranch_scc1 L_fin
    v_cmp_gt_u32 vcc, 160, v0
    s_and_saveexec_b64 s[78:79], vcc
    ds_read_b128 v[48:51], v34 offset:4864
    ds_read_b128 v[52:55], v34 offset:7424
    ds_read_b128 v[56:59], v34 offset:9984
    ds_read_b128 v[60:63], v34 offset:12544
    ds_read_b128 v[64:67], v34 offset:15104
    ds_read_b128 v[68:71], v34 offset:17664
    ds_read_b128 v[72:75], v34 offset:20224
    ds_read_b128 v[76:79], v34 offset:22784
    s_waitcnt lgkmcnt(4)
    v_pk_add_f32 v[48:49], v[48:49], v[52:53]
    v_pk_add_f32 v[50:51], v[50:51], v[54:55]
    v_pk_add_f32 v[56:57], v[56:57], v[60:61]
    v_pk_add_f32 v[58:59], v[58:59], v[62:63]
    v_pk_add_f32 v[48:49], v[48:49], v[56:57]
    v_pk_add_f32 v[50:51], v[50:51], v[58:59]
    s_waitcnt lgkmcnt(0)
    v_pk_add_f32 v[64:65], v[64:65], v[68:69]
    v_pk_add_f32 v[66:67], v[66:67], v[70:71]
    v_pk_add_f32 v[72:73], v[72:73], v[76:77]
    v_pk_add_f32 v[74:75], v[74:75], v[78:79]
    v_pk_add_f32 v[64:65], v[64:65], v[72:73]
    v_pk_add_f32 v[66:67], v[66:67], v[74:75]
    v_pk_add_f32 v[48:49], v[48:49], v[64:65]
    v_pk_add_f32 v[50:51], v[50:51], v[66:67]
    v_and_or_b32 v48, v48, -16, s16
    v_and_or_b32 v49, v49, -16, s17
    v_and_or_b32 v50, v50, -16, s18
    v_and_or_b32 v51, v51, -16, s19
    buffer_store_dwordx4 v[48:51], v34, s[40:43], s76 offen sc1
    s_mov_b64 exec, -1
    s_branch L_done
L_fin:
    s_cmp_lg_u32 s3, 5
    s_cbranch_scc1 L_done
    s_mov_b32 s80, 0
    s_mov_b32 s52, s22
    s_mov_b32 s53, s23
    s_mov_b32 s54, 0xa00
    s_mov_b32 s55, 0x20000
    v_lshrrev_b32 v36, 2, v1
    v_mul_u32_u24 v36, 32256, v36
    v_and_b32 v37, 3, v1
    v_lshl_add_u32 v36, v37, 7, v36
    s_cmp_ge_u32 s83, 40
    s_cselect_b32 s61, 1032192, 0
    s_add_u32 s61, s61, 4608
    s_add_u32 s62, s61, 516096
L_fl_poll:
    buffer_load_dword v37, v36, s[40:43], s61 offen sc1
    buffer_load_dword v38, v36, s[40:43], s62 offen sc1
    s_waitcnt vmcnt(0)
    v_cmp_ne_u32 vcc, s15, v37
    v_cmp_ne_u32 s[78:79], s15, v38
    s_or_b64 vcc, vcc, s[78:79]
    s_cbranch_scc0 L_fl_ok
    s_sleep 1
    s_add_u32 s80, s80, 1
    s_cmp_lt_u32 s80, 0x10000
    s_cbranch_scc1 L_fl_poll
L_fl_ok:
    s_mov_b32 s80, 0
L_fin_poll:
    s_mov_b32 s62, s63
    buffer_load_dwordx4 v[48:51], v45, s[40:43], s62 offen sc1
    s_add_u32 s62, s62, 129024
    buffer_load_dwordx4 v[52:55], v45, s[40:43], s62 offen sc1
    s_add_u32 s62, s62, 129024
    buffer_load_dwordx4 v[56:59], v45, s[40:43], s62 offen sc1
    s_add_u32 s62, s62, 129024
    buffer_load_dwordx4 v[60:63], v45, s[40:43], s62 offen sc1
    s_add_u32 s62, s62, 129024
    buffer_load_dwordx4 v[64:67], v45, s[40:43], s62 offen sc1
    s_add_u32 s62, s62, 129024
    buffer_load_dwordx4 v[68:71], v45, s[40:43], s62 offen sc1
    s_add_u32 s62, s62, 129024
    buffer_load_dwordx4 v[72:75], v45, s[40:43], s62 offen sc1
    s_add_u32 s62, s62, 129024
    buffer_load_dwordx4 v[76:79], v45, s[40:43], s62 offen sc1
L_fin_chk:
    s_waitcnt vmcnt(7)
    v_xor_b32 v48, s16, v48
    v_xor_b32 v49, s17, v49
    v_xor_b32 v50, s18, v50
    v_xor_b32 v51, s19, v51
    v_or3_b32 v36, v48, v49, v50
    v_or_b32 v36, v36, v51
    s_waitcnt vmcnt(6)
    v_xor_b32 v52, s16, v52
    v_xor_b32 v53, s17, v53
    v_xor_b32 v54, s18, v54
    v_xor_b32 v55, s19, v55
    v_or3_b32 v36, v36, v52, v53
    v_or3_b32 v36, v36, v54, v55
    v_pk_add_f32 v[48:49], v[48:49], v[52:53]
    v_pk_add_f32 v[50:51], v[50:51], v[54:55]
    s_waitcnt vmcnt(5)
    v_xor_b32 v56, s16, v56
    v_xor_b32 v57, s17, v57
    v_xor_b32 v58, s18, v58
    v_xor_b32 v59, s19, v59
    v_or3_b32 v36, v36, v56, v57
    v_or3_b32 v36, v36, v58, v59
    v_pk_add_f32 v[48:49], v[48:49], v[56:57]
    v_pk_add_f32 v[50:51], v[50:51], v[58:59]
    s_waitcnt vmcnt(4)
    v_xor_b32 v60, s16, v60
    v_xor_b32 v61, s17, v61
    v_xor_b32 v62, s18, v62
    v_xor_b32 v63, s19, v63
    v_or3_b32 v36, v36, v60, v61
    v_or3_b32 v36, v36, v62, v63
    v_pk_add_f32 v[48:49], v[48:49], v[60:61]
    v_pk_add_f32 v[50:51], v[50:51], v[62:63]
    s_waitcnt vmcnt(3)
    v_xor_b32 v64, s16, v64
    v_xor_b32 v65, s17, v65
    v_xor_b32 v66, s18, v66
    v_xor_b32 v67, s19, v67
    v_or3_b32 v36, v36, v64, v65
    v_or3_b32 v36, v36, v66, v67
    v_pk_add_f32 v[48:49], v[48:49], v[64:65]
    v_pk_add_f32 v[50:51], v[50:51], v[66:67]
    s_waitcnt vmcnt(2)
    v_xor_b32 v68, s16, v68
    v_xor_b32 v69, s17, v69
    v_xor_b32 v70, s18, v70
    v_xor_b32 v71, s19, v71
    v_or3_b32 v36, v36, v68, v69
    v_or3_b32 v36, v36, v70, v71
    v_pk_add_f32 v[48:49], v[48:49], v[68:69]
    v_pk_add_f32 v[50:51], v[50:51], v[70:71]
    s_waitcnt vmcnt(1)
    v_xor_b32 v72, s16, v72
    v_xor_b32 v73, s17, v73
    v_xor_b32 v74, s18, v74
    v_xor_b32 v75, s19, v75
    v_or3_b32 v36, v36, v72, v73
    v_or3_b32 v36, v36, v74, v75
    v_pk_add_f32 v[48:49], v[48:49], v[72:73]
    v_pk_add_f32 v[50:51], v[50:51], v[74:75]
    s_waitcnt vmcnt(0)
    v_xor_b32 v76, s16, v76
    v_xor_b32 v77, s17, v77
    v_xor_b32 v78, s18, v78
    v_xor_b32 v79, s19, v79
    v_or3_b32 v36, v36, v76, v77
    v_or3_b32 v36, v36, v78, v79
    v_pk_add_f32 v[48:49], v[48:49], v[76:77]
    v_pk_add_f32 v[50:51], v[50:51], v[78:79]
    v_and_b32 v36, 15, v36
    v_cmp_ne_u32 vcc, 0, v36
    s_cmp_eq_u64 vcc, 0
    s_cbranch_scc1 L_fin_ok
    s_sleep 4
    s_add_u32 s80, s80, 1
    s_cmp_lt_u32 s80, 0x10000
    s_cbranch_scc1 L_fin_poll
L_fin_ok:
    s_nop 1
    v_add_f32_dpp v36, v48, v48 row_ror:8 row_mask:0xf bank_mask:0x3
    v_add_f32_dpp v36, v49, v49 row_ror:8 row_mask:0xf bank_mask:0xc
    v_add_f32_dpp v37, v50, v50 row_ror:8 row_mask:0xf bank_mask:0x3
    v_add_f32_dpp v37, v51, v51 row_ror:8 row_mask:0xf bank_mask:0xc
    v_add_f32_dpp v38, v36, v36 row_shl:4 row_mask:0xf bank_mask:0x5
    s_nop 0
    v_add_f32_dpp v38, v37, v37 row_shr:4 row_mask:0xf bank_mask:0xa
    v_mov_b32 v36, v38
    s_nop 1
    v_permlane16_swap_b32 v38, v36
    v_add_f32 v38, v38, v36
    v_mov_b32 v36, v38
    s_nop 1
    v_permlane32_swap_b32 v38, v36
    v_add_f32 v38, v38, v36
    v_cvt_pk_bf16_f32 v38, v38, v38
    v_lshlrev_b32 v38, 16, v38
    v_add_f32 v38, v46, v38
    v_cvt_pk_bf16_f32 v38, v38, v38
    v_lshlrev_b32 v38, 16, v38
    v_add_f32 v38, v47, v38
    v_cvt_pk_bf16_f32 v38, v38, v38
    s_mov_b64 exec, 0xffff
    buffer_store_short v38, v23, s[52:55], 0 offen
    s_cmp_lg_u32 s83, 40
    s_cbranch_scc1 L_noep
    s_mov_b64 exec, 1
    buffer_store_dword v33, v32, s[40:43], s101 offen sc1
L_noep:
    s_mov_b64 exec, -1
L_done:
L_end:
    s_endpgm
L_s1:
    v_and_b32 v44, 0x30, v2
    v_lshlrev_b32 v45, 1, v43
    s_mul_i32 s77, s81, 32256
    s_add_u32 s77, s77, 4096
    buffer_load_dwordx4 v[10:13], v44, s[40:43], s77 offen sc1
    s_branch L_vphase
L_w2stats:
    s_setprio 3
    s_mov_b32 s80, 0
    s_branch L_w2_chk
L_w2_poll:
    buffer_load_dwordx4 v[10:13], v44, s[40:43], s77 offen sc1
L_w2_chk:
    s_waitcnt vmcnt(0)
    v_cmp_ne_u32 vcc, s15, v12
    v_cmp_ne_u32 s[78:79], s15, v13
    s_or_b64 vcc, vcc, s[78:79]
    s_cbranch_scc0 L_w2_ok
    s_sleep 8
    s_add_u32 s80, s80, 1
    s_cmp_lt_u32 s80, 0x10000
    s_cbranch_scc1 L_w2_poll
L_w2_ok:
    ds_read_b32 v39, v45 offset:33792
    v_mov_b32 v38, v10
    s_nop 1
    v_max_f32_dpp v38, v38, v38 quad_perm:[1,0,3,2] row_mask:0xf bank_mask:0xf
    s_nop 1
    v_max_f32_dpp v38, v38, v38 quad_perm:[2,3,0,1] row_mask:0xf bank_mask:0xf
    v_sub_f32 v36, v10, v38
    v_exp_f32 v36, v36
    s_nop 0
    v_mul_f32 v37, v36, v11
    s_nop 1
    v_add_f32_dpp v37, v37, v37 quad_perm:[1,0,3,2] row_mask:0xf bank_mask:0xf
    s_nop 1
    v_add_f32_dpp v37, v37, v37 quad_perm:[2,3,0,1] row_mask:0xf bank_mask:0xf
    v_rcp_f32 v37, v37
    s_waitcnt lgkmcnt(0)
    v_sub_f32 v36, v39, v38
    v_exp_f32 v36, v36
    s_nop 0
    v_mul_f32 v36, v36, v37
    ds_write_b32 v43, v36 offset:320
    s_branch L_bar2
L_c1:
    s_cmp_ge_u32 s83, 40
    s_cselect_b32 s61, 1, 0
    s_mul_i32 s62, s61, 40
    s_sub_u32 s62, s83, s62
    s_mul_i32 s63, s61, 1032192
    s_lshl_b32 s74, s62, 6
    s_add_u32 s63, s63, s74
    s_add_u32 s63, s63, 10240
    v_lshrrev_b32 v36, 2, v1
    v_and_b32 v37, 3, v1
    v_and_b32 v45, 3, v36
    v_mul_u32_u24 v45, 2560, v45
    v_mul_u32_u24 v38, 32256, v3
    v_add_u32 v45, v38, v45
    v_lshl_add_u32 v45, v37, 4, v45
    v_mul_u32_u24 v44, 64512, v36
    v_lshl_add_u32 v44, v37, 4, v44
    s_lshr_b32 s75, s62, 3
    s_lshl_b32 s75, s75, 10
    s_lshl_b32 s74, s61, 9
    s_add_u32 s75, s75, s74
    s_and_b32 s74, s62, 7
    s_lshl_b32 s74, s74, 6
    s_add_u32 s75, s75, s74
    s_add_u32 s75, s75, 5120
    s_add_u32 s77, s75, 1032192
    v_and_b32 v38, 1, v36
    v_lshlrev_b32 v38, 1, v38
    v_bfe_u32 v39, v36, 1, 1
    v_or_b32 v38, v38, v39
    v_lshl_add_u32 v38, v37, 3, v38
    v_lshlrev_b32 v38, 1, v38
    s_mul_i32 s61, s61, 1280
    s_lshr_b32 s74, s62, 3
    s_lshl_b32 s74, s74, 8
    s_add_u32 s61, s61, s74
    s_and_b32 s74, s62, 3
    s_lshl_b32 s74, s74, 6
    s_add_u32 s61, s61, s74
    s_and_b32 s74, s62, 4
    s_lshl_b32 s74, s74, 1
    s_add_u32 s61, s61, s74
    v_add_u32 v23, s61, v38
    s_mov_b32 s48, s4
    s_mov_b32 s49, s5
    s_mov_b32 s50, 0xa00
    s_mov_b32 s51, 0x20000
    buffer_load_ushort v46, v23, s[48:51], 0 offen
    v_mov_b32 v36, s16
    v_mov_b32 v37, s17
    v_mov_b32 v38, s18
    v_mov_b32 v39, s19
    buffer_load_dwordx4 v[10:13], v44, s[40:43], s75 offen sc1
    s_mov_b32 exec_hi, 0xfff
    buffer_load_dwordx4 v[36:39], v44, s[40:43], s77 offen sc1
    s_mov_b32 exec_hi, -1
    s_branch L_vphase
L_w3pre:
    s_setprio 3
    s_mov_b32 s80, 0
    s_branch L_w3_chk
L_w3_poll:
    v_mov_b32 v36, s16
    v_mov_b32 v37, s17
    v_mov_b32 v38, s18
    v_mov_b32 v39, s19
    buffer_load_dwordx4 v[10:13], v44, s[40:43], s75 offen sc1
    s_mov_b32 exec_hi, 0xfff
    buffer_load_dwordx4 v[36:39], v44, s[40:43], s77 offen sc1
    s_mov_b32 exec_hi, -1
L_w3_chk:
    s_waitcnt vmcnt(0)
    v_xor_b32 v10, s16, v10
    v_xor_b32 v11, s17, v11
    v_xor_b32 v12, s18, v12
    v_xor_b32 v13, s19, v13
    v_xor_b32 v36, s16, v36
    v_xor_b32 v37, s17, v37
    v_xor_b32 v38, s18, v38
    v_xor_b32 v39, s19, v39
    v_or3_b32 v28, v10, v11, v12
    v_or3_b32 v28, v28, v13, v36
    v_or3_b32 v28, v28, v37, v38
    v_or_b32 v28, v28, v39
    v_and_b32 v28, 15, v28
    v_cmp_ne_u32 vcc, 0, v28
    s_cmp_eq_u64 vcc, 0
    s_cbranch_scc1 L_w3_ok
    s_sleep 16
    s_add_u32 s80, s80, 1
    s_cmp_lt_u32 s80, 0x10000
    s_cbranch_scc1 L_w3_poll
L_w3_ok:
    v_pk_add_f32 v[10:11], v[10:11], v[36:37]
    v_pk_add_f32 v[12:13], v[12:13], v[38:39]
    s_nop 1
    v_add_f32_dpp v28, v10, v10 row_ror:8 row_mask:0xf bank_mask:0x3
    v_add_f32_dpp v28, v11, v11 row_ror:8 row_mask:0xf bank_mask:0xc
    v_add_f32_dpp v29, v12, v12 row_ror:8 row_mask:0xf bank_mask:0x3
    v_add_f32_dpp v29, v13, v13 row_ror:8 row_mask:0xf bank_mask:0xc
    v_add_f32_dpp v47, v28, v28 row_shl:4 row_mask:0xf bank_mask:0x5
    s_nop 0
    v_add_f32_dpp v47, v29, v29 row_shr:4 row_mask:0xf bank_mask:0xa
    v_mov_b32 v28, v47
    s_nop 1
    v_permlane16_swap_b32 v47, v28
    v_add_f32 v47, v47, v28
    v_mov_b32 v28, v47
    s_nop 1
    v_permlane32_swap_b32 v47, v28
    v_add_f32 v47, v47, v28
    v_cvt_pk_bf16_f32 v47, v47, v47
    v_lshlrev_b32 v47, 16, v47
    v_lshlrev_b32 v46, 16, v46
    s_branch L_bar2
L_unit2:
    v_and_b32 v36, 1, v1
    v_lshlrev_b32 v36, 4, v36
    v_mov_b32 v37, 0xffff
    v_lshlrev_b32 v36, v36, v37
    v_bfe_u32 v37, v1, 1, 2
    v_cmp_eq_u32 vcc, 0, v37
    s_nop 1
    v_cndmask_b32 v6, 0, v36, vcc
    v_cmp_eq_u32 vcc, 1, v37
    s_nop 1
    v_cndmask_b32 v7, 0, v36, vcc
    v_cmp_eq_u32 vcc, 2, v37
    s_nop 1
    v_cndmask_b32 v8, 0, v36, vcc
    v_cmp_eq_u32 vcc, 3, v37
    s_nop 1
    v_cndmask_b32 v9, 0, v36, vcc
    s_cmp_lg_u32 s56, 5
    s_cbranch_scc1 L_unit3
    s_mov_b32 s61, 0xffff0000
    s_waitcnt vmcnt(10)
    v_lshlrev_b32 v96, 16, v24
    v_and_b32 v97, s61, v24
    v_lshlrev_b32 v98, 16, v25
    v_and_b32 v99, s61, v25
    v_lshlrev_b32 v100, 16, v26
    v_and_b32 v101, s61, v26
    v_lshlrev_b32 v102, 16, v27
    v_and_b32 v103, s61, v27
    v_lshlrev_b32 v104, 16, v28
    v_and_b32 v105, s61, v28
    v_lshlrev_b32 v106, 16, v29
    v_and_b32 v107, s61, v29
    v_lshlrev_b32 v108, 16, v30
    v_and_b32 v109, s61, v30
    v_lshlrev_b32 v110, 16, v31
    v_and_b32 v111, s61, v31
    v_lshlrev_b32 v112, 16, v32
    v_and_b32 v113, s61, v32
    v_lshlrev_b32 v114, 16, v33
    v_and_b32 v115, s61, v33
    v_add_f32 v14, v96, v97
    v_add_f32 v15, v98, v99
    v_add_f32 v14, v14, v100
    v_add_f32 v15, v15, v101
    v_add_f32 v14, v14, v102
    v_add_f32 v15, v15, v103
    v_add_f32 v14, v14, v104
    v_add_f32 v15, v15, v105
    v_add_f32 v14, v14, v106
    v_add_f32 v15, v15, v107
    v_add_f32 v14, v14, v108
    v_add_f32 v15, v15, v109
    v_add_f32 v14, v14, v110
    v_add_f32 v15, v15, v111
    v_add_f32 v14, v14, v112
    v_add_f32 v15, v15, v113
    v_add_f32 v14, v14, v114
    v_add_f32 v15, v15, v115
    v_add_f32 v14, v14, v15
    s_nop 1
    v_add_f32_dpp v14, v14, v14 quad_perm:[1,0,3,2] row_mask:0xf bank_mask:0xf
    s_nop 1
    v_add_f32_dpp v14, v14, v14 quad_perm:[2,3,0,1] row_mask:0xf bank_mask:0xf
    s_nop 1
    v_add_f32_dpp v14, v14, v14 row_half_mirror row_mask:0xf bank_mask:0xf
    s_nop 1
    v_add_f32_dpp v14, v14, v14 row_mirror row_mask:0xf bank_mask:0xf
    v_mov_b32 v15, v14
    s_nop 1
    v_permlane16_swap_b32 v14, v15
    v_add_f32 v14, v14, v15
    s_mov_b32 s62, 0x3acccccd
    v_mul_f32 v14, s62, v14
    v_sub_f32 v116, v96, v14
    v_sub_f32 v117, v97, v14
    v_sub_f32 v118, v98, v14
    v_sub_f32 v119, v99, v14
    v_sub_f32 v120, v100, v14
    v_sub_f32 v121, v101, v14
    v_sub_f32 v122, v102, v14
    v_sub_f32 v123, v103, v14
    v_sub_f32 v124, v104, v14
    v_sub_f32 v125, v105, v14
    v_sub_f32 v126, v106, v14
    v_sub_f32 v127, v107, v14
    v_sub_f32 v128, v108, v14
    v_sub_f32 v129, v109, v14
    v_sub_f32 v130, v110, v14
    v_sub_f32 v131, v111, v14
    v_sub_f32 v132, v112, v14
    v_sub_f32 v133, v113, v14
    v_sub_f32 v134, v114, v14
    v_sub_f32 v135, v115, v14
    v_mul_f32 v16, v116, v116
    v_mul_f32 v17, v117, v117
    v_fmac_f32 v16, v118, v118
    v_fmac_f32 v17, v119, v119
    v_fmac_f32 v16, v120, v120
    v_fmac_f32 v17, v121, v121
    v_fmac_f32 v16, v122, v122
    v_fmac_f32 v17, v123, v123
    v_fmac_f32 v16, v124, v124
    v_fmac_f32 v17, v125, v125
    v_fmac_f32 v16, v126, v126
    v_fmac_f32 v17, v127, v127
    v_fmac_f32 v16, v128, v128
    v_fmac_f32 v17, v129, v129
    v_fmac_f32 v16, v130, v130
    v_fmac_f32 v17, v131, v131
    v_fmac_f32 v16, v132, v132
    v_fmac_f32 v17, v133, v133
    v_fmac_f32 v16, v134, v134
    v_fmac_f32 v17, v135, v135
    v_add_f32 v16, v16, v17
    s_nop 1
    v_add_f32_dpp v16, v16, v16 quad_perm:[1,0,3,2] row_mask:0xf bank_mask:0xf
    s_nop 1
    v_add_f32_dpp v16, v16, v16 quad_perm:[2,3,0,1] row_mask:0xf bank_mask:0xf
    s_nop 1
    v_add_f32_dpp v16, v16, v16 row_half_mirror row_mask:0xf bank_mask:0xf
    s_nop 1
    v_add_f32_dpp v16, v16, v16 row_mirror row_mask:0xf bank_mask:0xf
    v_mov_b32 v15, v16
    s_nop 1
    v_permlane16_swap_b32 v16, v15
    v_add_f32 v16, v16, v15
    v_mul_f32 v16, s62, v16
    v_cvt_pk_bf16_f32 v15, v14, v16
    v_lshlrev_b32 v14, 16, v15
    v_and_b32 v16, s61, v15
    v_add_f32 v16, 0x3727c5ac, v16
    v_cvt_pk_bf16_f32 v16, v16, v16
    v_and_b32 v16, s61, v16
    v_sqrt_f32 v16, v16
    s_nop 0
    v_cvt_pk_bf16_f32 v16, v16, v16
    v_and_b32 v16, s61, v16
    v_rcp_f32 v16, v16
    v_sub_f32 v96, v96, v14
    v_sub_f32 v97, v97, v14
    v_sub_f32 v98, v98, v14
    v_sub_f32 v99, v99, v14
    v_sub_f32 v100, v100, v14
    v_sub_f32 v101, v101, v14
    v_sub_f32 v102, v102, v14
    v_sub_f32 v103, v103, v14
    v_sub_f32 v104, v104, v14
    v_sub_f32 v105, v105, v14
    v_sub_f32 v106, v106, v14
    v_sub_f32 v107, v107, v14
    v_sub_f32 v108, v108, v14
    v_sub_f32 v109, v109, v14
    v_sub_f32 v110, v110, v14
    v_sub_f32 v111, v111, v14
    v_sub_f32 v112, v112, v14
    v_sub_f32 v113, v113, v14
    v_sub_f32 v114, v114, v14
    v_sub_f32 v115, v115, v14
    v_cvt_pk_bf16_f32 v24, v96, v97
    v_cvt_pk_bf16_f32 v25, v98, v99
    v_cvt_pk_bf16_f32 v26, v100, v101
    v_cvt_pk_bf16_f32 v27, v102, v103
    v_cvt_pk_bf16_f32 v28, v104, v105
    v_cvt_pk_bf16_f32 v29, v106, v107
    v_cvt_pk_bf16_f32 v30, v108, v109
    v_cvt_pk_bf16_f32 v31, v110, v111
    v_cvt_pk_bf16_f32 v32, v112, v113
    v_cvt_pk_bf16_f32 v33, v114, v115
    v_lshlrev_b32 v96, 16, v24
    v_and_b32 v97, s61, v24
    v_lshlrev_b32 v98, 16, v25
    v_and_b32 v99, s61, v25
    v_lshlrev_b32 v100, 16, v26
    v_and_b32 v101, s61, v26
    v_lshlrev_b32 v102, 16, v27
    v_and_b32 v103, s61, v27
    v_lshlrev_b32 v104, 16, v28
    v_and_b32 v105, s61, v28
    v_lshlrev_b32 v106, 16, v29
    v_and_b32 v107, s61, v29
    v_lshlrev_b32 v108, 16, v30
    v_and_b32 v109, s61, v30
    v_lshlrev_b32 v110, 16, v31
    v_and_b32 v111, s61, v31
    v_lshlrev_b32 v112, 16, v32
    v_and_b32 v113, s61, v32
    v_lshlrev_b32 v114, 16, v33
    v_and_b32 v115, s61, v33
    v_mul_f32 v96, v96, v16
    v_mul_f32 v97, v97, v16
    v_mul_f32 v98, v98, v16
    v_mul_f32 v99, v99, v16
    v_mul_f32 v100, v100, v16
    v_mul_f32 v101, v101, v16
    v_mul_f32 v102, v102, v16
    v_mul_f32 v103, v103, v16
    v_mul_f32 v104, v104, v16
    v_mul_f32 v105, v105, v16
    v_mul_f32 v106, v106, v16
    v_mul_f32 v107, v107, v16
    v_mul_f32 v108, v108, v16
    v_mul_f32 v109, v109, v16
    v_mul_f32 v110, v110, v16
    v_mul_f32 v111, v111, v16
    v_mul_f32 v112, v112, v16
    v_mul_f32 v113, v113, v16
    v_mul_f32 v114, v114, v16
    v_mul_f32 v115, v115, v16
    v_cvt_pk_bf16_f32 v24, v96, v97
    v_cvt_pk_bf16_f32 v25, v98, v99
    v_cvt_pk_bf16_f32 v26, v100, v101
    v_cvt_pk_bf16_f32 v27, v102, v103
    v_cvt_pk_bf16_f32 v28, v104, v105
    v_cvt_pk_bf16_f32 v29, v106, v107
    v_cvt_pk_bf16_f32 v30, v108, v109
    v_cvt_pk_bf16_f32 v31, v110, v111
    v_cvt_pk_bf16_f32 v32, v112, v113
    v_cvt_pk_bf16_f32 v33, v114, v115
    v_min_u32 v24, -2, v24
    v_min_u32 v25, -2, v25
    v_min_u32 v26, -2, v26
    v_min_u32 v27, -2, v27
    v_min_u32 v28, -2, v28
    v_min_u32 v29, -2, v29
    v_min_u32 v30, -2, v30
    v_min_u32 v31, -2, v31
    v_min_u32 v32, -2, v32
    v_min_u32 v33, -2, v33
    ds_write_b64 v12, v[24:25] offset:25344
    ds_write_b64 v12, v[26:27] offset:25600
    ds_write_b64 v12, v[28:29] offset:25856
    ds_write_b64 v12, v[30:31] offset:26112
    ds_write_b64 v12, v[32:33] offset:26368
L_unit3:
    v_bfe_u32 v36, v1, 3, 1
    v_mul_u32_u24 v36, 1280, v36
    v_lshl_add_u32 v37, v22, 1, v36
    s_mov_b32 s61, 0x01000100
    s_mov_b32 s62, 0x03020302
    s_waitcnt vmcnt(0)
    s_cmp_lg_u32 s56, 4
    s_cbranch_scc1 L_u2a
    v_mov_b32 v21, 0
    v_add_u32 v20, 1, v20
    v_and_b32 v20, 0x7fffffff, v20
    ds_write_b32 v21, v20 offset:256
    v_readfirstlane_b32 s15, v20
    s_nop 0
    s_bfe_u32 s16, s15, 0x40000
    s_bfe_u32 s17, s15, 0x40004
    s_bfe_u32 s18, s15, 0x40008
    s_bfe_u32 s19, s15, 0x4000c
L_u2a:
    s_mov_b32 s80, 0
L_u2x:
    ds_read_b32 v14, v37 offset:25344
    ds_read_b32 v15, v37 offset:25348
    ds_read_b32 v16, v37 offset:25352
    ds_read_b32 v17, v37 offset:25356
    ds_read_b32 v18, v37 offset:25360
    s_waitcnt lgkmcnt(0)
    v_max3_u32 v36, v14, v15, v16
    v_max3_u32 v36, v36, v17, v18
    v_cmp_eq_u32 vcc, -1, v36
    s_cmp_eq_u64 vcc, 0
    s_cbranch_scc1 L_u2b
    s_sleep 1
    s_add_u32 s80, s80, 1
    s_cmp_lt_u32 s80, 0x100000
    s_cbranch_scc1 L_u2x
L_u2b:
    v_perm_b32 v36, v14, v14, s61
    v_and_b32 v28, v36, v6
    v_and_b32 v29, v36, v7
    v_and_b32 v30, v36, v8
    v_and_b32 v31, v36, v9
    v_perm_b32 v36, v14, v14, s62
    v_and_b32 v32, v36, v6
    v_and_b32 v33, v36, v7
    v_and_b32 v34, v36, v8
    v_and_b32 v35, v36, v9
    v_mfma_f32_16x16x32_bf16 v[40:43], v[28:31], v[176:179], 0
    v_perm_b32 v36, v15, v15, s61
    v_and_b32 v28, v36, v6
    v_and_b32 v29, v36, v7
    v_and_b32 v30, v36, v8
    v_and_b32 v31, v36, v9
    v_mfma_f32_16x16x32_bf16 v[40:43], v[32:35], v[180:183], v[40:43]
    v_perm_b32 v36, v15, v15, s62
    v_and_b32 v32, v36, v6
    v_and_b32 v33, v36, v7
    v_and_b32 v34, v36, v8
    v_and_b32 v35, v36, v9
    v_mfma_f32_16x16x32_bf16 v[40:43], v[28:31], v[184:187], v[40:43]
    v_perm_b32 v36, v16, v16, s61
    v_and_b32 v28, v36, v6
    v_and_b32 v29, v36, v7
    v_and_b32 v30, v36, v8
    v_and_b32 v31, v36, v9
    v_mfma_f32_16x16x32_bf16 v[40:43], v[32:35], v[188:191], v[40:43]
    v_perm_b32 v36, v16, v16, s62
    v_and_b32 v32, v36, v6
    v_and_b32 v33, v36, v7
    v_and_b32 v34, v36, v8
    v_and_b32 v35, v36, v9
    v_mfma_f32_16x16x32_bf16 v[40:43], v[28:31], v[192:195], v[40:43]
    v_perm_b32 v36, v17, v17, s61
    v_and_b32 v28, v36, v6
    v_and_b32 v29, v36, v7
    v_and_b32 v30, v36, v8
    v_and_b32 v31, v36, v9
    v_mfma_f32_16x16x32_bf16 v[40:43], v[32:35], v[196:199], v[40:43]
    v_perm_b32 v36, v17, v17, s62
    v_and_b32 v32, v36, v6
    v_and_b32 v33, v36, v7
    v_and_b32 v34, v36, v8
    v_and_b32 v35, v36, v9
    v_mfma_f32_16x16x32_bf16 v[40:43], v[28:31], v[200:203], v[40:43]
    v_perm_b32 v36, v18, v18, s61
    v_and_b32 v28, v36, v6
    v_and_b32 v29, v36, v7
    v_and_b32 v30, v36, v8
    v_and_b32 v31, v36, v9
    v_mfma_f32_16x16x32_bf16 v[40:43], v[32:35], v[204:207], v[40:43]
    v_perm_b32 v36, v18, v18, s62
    v_and_b32 v32, v36, v6
    v_and_b32 v33, v36, v7
    v_and_b32 v34, v36, v8
    v_and_b32 v35, v36, v9
    v_mfma_f32_16x16x32_bf16 v[40:43], v[28:31], v[208:211], v[40:43]
    s_nop 0
    v_mfma_f32_16x16x32_bf16 v[40:43], v[32:35], v[212:215], v[40:43]
L_u8:
    s_cmp_eq_u32 s56, 4
    s_cbranch_scc1 L_u2c
    s_nop 5
    v_min_u32 v40, -2, v40
    v_min_u32 v41, -2, v41
    v_min_u32 v42, -2, v42
    v_min_u32 v43, -2, v43
    ds_write_b128 v13, v[40:43] offset:29440
    s_branch L_pref
L_u2c:
    s_nop 3
    s_mov_b32 s80, 0
L_u2w:
    ds_read_b128 v[28:31], v2 offset:30464
    ds_read_b128 v[32:35], v2 offset:31488
    ds_read_b128 v[36:39], v2 offset:32512
    s_waitcnt lgkmcnt(0)
    v_max3_u32 v44, v28, v29, v30
    v_max3_u32 v44, v44, v31, v32
    v_max3_u32 v44, v44, v33, v34
    v_max3_u32 v44, v44, v35, v36
    v_max3_u32 v44, v44, v37, v38
    v_max_u32 v44, v44, v39
    v_cmp_eq_u32 vcc, -1, v44
    s_cmp_eq_u64 vcc, 0
    s_cbranch_scc1 L_u2ok
    s_sleep 1
    s_add_u32 s80, s80, 1
    s_cmp_lt_u32 s80, 0x100000
    s_cbranch_scc1 L_u2w
L_u2ok:
    v_pk_add_f32 v[40:41], v[40:41], v[28:29]
    v_pk_add_f32 v[42:43], v[42:43], v[30:31]
    v_pk_add_f32 v[32:33], v[32:33], v[36:37]
    v_pk_add_f32 v[34:35], v[34:35], v[38:39]
    v_pk_add_f32 v[40:41], v[40:41], v[32:33]
    v_pk_add_f32 v[42:43], v[42:43], v[34:35]
    v_and_or_b32 v40, v40, -16, s16
    v_and_or_b32 v41, v41, -16, s17
    v_and_or_b32 v42, v42, -16, s18
    v_and_or_b32 v43, v43, -16, s19
    buffer_store_dwordx4 v[40:43], v2, s[40:43], s75 offen sc1
    s_branch L_pref
L_poller:
    s_setprio 3
    s_cmp_ge_i32 s66, 0
    s_cbranch_scc1 L_pn
    s_waitcnt vmcnt(12)
    v_add_u32 v20, 1, v20
    v_and_b32 v20, 0x7fffffff, v20
    ds_write_b32 v21, v20 offset:256
L_pn:
    s_mov_b32 s80, 0
L_pn2:
    ds_read_b32 v20, v21 offset:256
    s_waitcnt lgkmcnt(0)
    v_cmp_eq_u32 vcc, -1, v20
    s_cmp_eq_u64 vcc, 0
    s_cbranch_scc1 L_pn3
    s_sleep 2
    s_add_u32 s80, s80, 1
    s_cmp_lt_u32 s80, 0x100000
    s_cbranch_scc1 L_pn2
L_pn3:
    v_readfirstlane_b32 s15, v20
    s_nop 0
    s_bfe_u32 s16, s15, 0x40000
    s_bfe_u32 s17, s15, 0x40004
    s_bfe_u32 s18, s15, 0x40008
    s_bfe_u32 s19, s15, 0x4000c
    v_lshrrev_b32 v18, 5, v1
    v_lshlrev_b32 v18, 10, v18
    v_and_b32 v19, 0x1f0, v2
    v_add_u32 v18, v18, v19
    v_and_b32 v19, 1, v3
    v_lshlrev_b32 v19, 3, v19
    v_lshl_add_u32 v19, v4, 4, v19
    s_mul_i32 s61, s57, 32256
    s_lshl_b32 s62, s58, 9
    s_add_u32 s61, s61, s62
    s_mov_b32 s80, 0
L_w0_poll:
    buffer_load_dwordx4 v[28:31], v18, s[40:43], s61 offen sc1
    buffer_load_dwordx4 v[32:35], v18, s[40:43], s61 offen offset:2048 sc1
    s_waitcnt vmcnt(0)
    v_xor_b32 v28, s16, v28
    v_xor_b32 v29, s17, v29
    v_xor_b32 v30, s18, v30
    v_xor_b32 v31, s19, v31
    v_xor_b32 v32, s16, v32
    v_xor_b32 v33, s17, v33
    v_xor_b32 v34, s18, v34
    v_xor_b32 v35, s19, v35
    v_or3_b32 v16, v28, v29, v30
    v_or3_b32 v16, v16, v31, v32
    v_or3_b32 v16, v16, v33, v34
    v_or_b32 v16, v16, v35
    v_and_b32 v16, 15, v16
    v_cmp_ne_u32 vcc, 0, v16
    s_cmp_eq_u64 vcc, 0
    s_cbranch_scc1 L_w0_ok
    s_sleep 8
    s_add_u32 s80, s80, 1
    s_cmp_lt_u32 s80, 0x10000
    s_cbranch_scc1 L_w0_poll
L_w0_ok:
    v_pk_add_f32 v[28:29], v[28:29], v[32:33]
    v_pk_add_f32 v[30:31], v[30:31], v[34:35]
    v_mov_b32 v32, v28
    v_mov_b32 v33, v29
    v_mov_b32 v34, v30
    v_mov_b32 v35, v31
    s_nop 0
    v_permlane32_swap_b32 v28, v32
    v_permlane32_swap_b32 v29, v33
    v_permlane32_swap_b32 v30, v34
    v_permlane32_swap_b32 v31, v35
    v_pk_add_f32 v[28:29], v[28:29], v[32:33]
    v_pk_add_f32 v[30:31], v[30:31], v[34:35]
    v_cvt_pk_bf16_f32 v28, v28, v29
    v_cvt_pk_bf16_f32 v29, v30, v31
    v_min_u32 v28, -2, v28
    v_min_u32 v29, -2, v29
    ds_write_b64 v19, v[28:29] offset:0
    s_branch L_extras
L_wdown:
    s_mov_b32 s52, s20
    s_mov_b32 s53, s21
    s_mov_b32 s54, 0x21c000
    s_mov_b32 s55, 0x20000
    s_mul_i32 s77, s83, 205
    s_lshr_b32 s77, s77, 10
    s_mul_i32 s62, s77, 5
    s_sub_u32 s62, s83, s62
    s_lshl_b32 s62, s62, 8
    s_mul_i32 s61, s77, 81920
    s_add_u32 s61, s61, s62
    v_mul_u32_u24 v39, 20480, v3
    v_lshl_add_u32 v39, v4, 4, v39
    buffer_load_dwordx4 v[176:179], v39, s[52:55], s61 offen offset:0 nt
    s_nop 0
    buffer_load_dwordx4 v[180:183], v39, s[52:55], s61 offen offset:1280 nt
    s_nop 0
    buffer_load_dwordx4 v[184:187], v39, s[52:55], s61 offen offset:2560 nt
    s_nop 0
    buffer_load_dwordx4 v[188:191], v39, s[52:55], s61 offen offset:3840 nt
    s_add_u32 s61, s61, 5120
    buffer_load_dwordx4 v[192:195], v39, s[52:55], s61 offen offset:0 nt
    s_nop 0
    buffer_load_dwordx4 v[196:199], v39, s[52:55], s61 offen offset:1280 nt
    s_nop 0
    buffer_load_dwordx4 v[200:203], v39, s[52:55], s61 offen offset:2560 nt
    s_nop 0
    buffer_load_dwordx4 v[204:207], v39, s[52:55], s61 offen offset:3840 nt
    s_add_u32 s61, s61, 5120
    buffer_load_dwordx4 v[208:211], v39, s[52:55], s61 offen offset:0 nt
    s_nop 0
    buffer_load_dwordx4 v[212:215], v39, s[52:55], s61 offen offset:1280 nt
    s_nop 0
    buffer_load_dwordx4 v[216:219], v39, s[52:55], s61 offen offset:2560 nt
    s_nop 0
    buffer_load_dwordx4 v[220:223], v39, s[52:55], s61 offen offset:3840 nt
    s_add_u32 s61, s61, 5120
    buffer_load_dwordx4 v[224:227], v39, s[52:55], s61 offen offset:0 nt
    s_nop 0
    buffer_load_dwordx4 v[228:231], v39, s[52:55], s61 offen offset:1280 nt
    s_nop 0
    buffer_load_dwordx4 v[232:235], v39, s[52:55], s61 offen offset:2560 nt
    s_nop 0
    buffer_load_dwordx4 v[236:239], v39, s[52:55], s61 offen offset:3840 nt
    s_add_u32 s61, s61, 5120
    s_branch L_qw
L_ffn2:
    s_add_u32 s61, s77, 32
    s_mul_i32 s61, s61, 32256
    s_mov_b32 s80, 0
L_w1_poll:
    buffer_load_dwordx4 v[48:51], v2, s[40:43], s61 offen offset:0 sc1
    buffer_load_dwordx4 v[52:55], v2, s[40:43], s61 offen offset:1024 sc1
    buffer_load_dwordx4 v[56:59], v2, s[40:43], s61 offen offset:2048 sc1
    buffer_load_dwordx4 v[60:63], v2, s[40:43], s61 offen offset:3072 sc1
L_w1_chk:
    s_waitcnt vmcnt(0)
    v_xor_b32 v48, s16, v48
    v_xor_b32 v49, s17, v49
    v_xor_b32 v50, s18, v50
    v_xor_b32 v51, s19, v51
    v_xor_b32 v52, s16, v52
    v_xor_b32 v53, s17, v53
    v_xor_b32 v54, s18, v54
    v_xor_b32 v55, s19, v55
    v_xor_b32 v56, s16, v56
    v_xor_b32 v57, s17, v57
    v_xor_b32 v58, s18, v58
    v_xor_b32 v59, s19, v59
    v_xor_b32 v60, s16, v60
    v_xor_b32 v61, s17, v61
    v_xor_b32 v62, s18, v62
    v_xor_b32 v63, s19, v63
    v_or3_b32 v77, v48, v49, v50
    v_or3_b32 v77, v77, v51, v52
    v_or3_b32 v77, v77, v53, v54
    v_or3_b32 v77, v77, v55, v56
    v_or3_b32 v77, v77, v57, v58
    v_or3_b32 v77, v77, v59, v60
    v_or3_b32 v77, v77, v61, v62
    v_or_b32 v77, v77, v63
    v_and_b32 v77, 15, v77
    v_cmp_ne_u32 vcc, 0, v77
    s_cmp_eq_u64 vcc, 0
    s_cbranch_scc1 L_w1_ok
    s_sleep 8
    s_add_u32 s80, s80, 1
    s_cmp_lt_u32 s80, 0x10000
    s_cbranch_scc1 L_w1_poll
L_w1_ok:
    v_pk_add_f32 v[48:49], v[48:49], v[52:53]
    v_pk_add_f32 v[50:51], v[50:51], v[54:55]
    v_pk_add_f32 v[56:57], v[56:57], v[60:61]
    v_pk_add_f32 v[58:59], v[58:59], v[62:63]
    v_pk_add_f32 v[48:49], v[48:49], v[56:57]
    v_pk_add_f32 v[50:51], v[50:51], v[58:59]
    v_and_b32 v77, 8, v1
    v_cmp_eq_u32 vcc, 0, v77
    s_mov_b32 s61, 0xffff0000
    v_mov_b32_dpp v64, v48 row_ror:8 row_mask:0xf bank_mask:0xf
    v_mov_b32_dpp v65, v49 row_ror:8 row_mask:0xf bank_mask:0xf
    v_mov_b32_dpp v66, v50 row_ror:8 row_mask:0xf bank_mask:0xf
    v_mov_b32_dpp v67, v51 row_ror:8 row_mask:0xf bank_mask:0xf
    v_cndmask_b32 v68, v64, v48, vcc
    v_cndmask_b32 v72, v48, v64, vcc
    v_cndmask_b32 v69, v65, v49, vcc
    v_cndmask_b32 v73, v49, v65, vcc
    v_cndmask_b32 v70, v66, v50, vcc
    v_cndmask_b32 v74, v50, v66, vcc
    v_cndmask_b32 v71, v67, v51, vcc
    v_cndmask_b32 v75, v51, v67, vcc
    s_mov_b32 s62, 0x3d372713
    s_mov_b32 s74, 0xc0135761
    v_cvt_pk_bf16_f32 v76, v68, v72
    v_lshlrev_b32 v68, 16, v76
    v_and_b32 v72, s61, v76
    v_mul_f32 v77, v68, v68
    v_mul_f32 v77, s62, v77
    v_fma_f32 v77, v77, v68, v68
    v_mul_f32 v77, s74, v77
    v_exp_f32 v77, v77
    s_nop 0
    v_add_f32 v77, 1.0, v77
    v_rcp_f32 v77, v77
    s_nop 0
    v_mul_f32 v77, v68, v77
    v_cvt_pk_bf16_f32 v77, v77, v77
    v_and_b32 v77, s61, v77
    v_mul_f32 v68, v77, v72
    v_cvt_pk_bf16_f32 v76, v69, v73
    v_lshlrev_b32 v69, 16, v76
    v_and_b32 v73, s61, v76
    v_mul_f32 v77, v69, v69
    v_mul_f32 v77, s62, v77
    v_fma_f32 v77, v77, v69, v69
    v_mul_f32 v77, s74, v77
    v_exp_f32 v77, v77
    s_nop 0
    v_add_f32 v77, 1.0, v77
    v_rcp_f32 v77, v77
    s_nop 0
    v_mul_f32 v77, v69, v77
    v_cvt_pk_bf16_f32 v77, v77, v77
    v_and_b32 v77, s61, v77
    v_mul_f32 v69, v77, v73
    v_cvt_pk_bf16_f32 v76, v70, v74
    v_lshlrev_b32 v70, 16, v76
    v_and_b32 v74, s61, v76
    v_mul_f32 v77, v70, v70
    v_mul_f32 v77, s62, v77
    v_fma_f32 v77, v77, v70, v70
    v_mul_f32 v77, s74, v77
    v_exp_f32 v77, v77
    s_nop 0
    v_add_f32 v77, 1.0, v77
    v_rcp_f32 v77, v77
    s_nop 0
    v_mul_f32 v77, v70, v77
    v_cvt_pk_bf16_f32 v77, v77, v77
    v_and_b32 v77, s61, v77
    v_mul_f32 v70, v77, v74
    v_cvt_pk_bf16_f32 v76, v71, v75
    v_lshlrev_b32 v71, 16, v76
    v_and_b32 v75, s61, v76
    v_mul_f32 v77, v71, v71
    v_mul_f32 v77, s62, v77
    v_fma_f32 v77, v77, v71, v71
    v_mul_f32 v77, s74, v77
    v_exp_f32 v77, v77
    s_nop 0
    v_add_f32 v77, 1.0, v77
    v_rcp_f32 v77, v77
    s_nop 0
    v_mul_f32 v77, v71, v77
    v_cvt_pk_bf16_f32 v77, v77, v77
    v_and_b32 v77, s61, v77
    v_mul_f32 v71, v77, v75
    v_cvt_pk_bf16_f32 v72, v68, v69
    v_cvt_pk_bf16_f32 v73, v70, v71
    v_lshrrev_b32 v76, 1, v3
    v_lshlrev_b32 v76, 7, v76
    v_and_b32 v77, 7, v1
    v_lshl_add_u32 v76, v77, 4, v76
    v_and_b32 v77, 1, v3
    v_lshl_add_u32 v76, v77, 3, v76
    ds_write_b64 v76, v[72:73] offset:33536
    v_bfe_u32 v77, v1, 3, 1
    v_lshlrev_b32 v77, 7, v77
    v_lshl_add_u32 v77, v3, 5, v77
    ds_read_b128 v[80:83], v77 offset:33536
    ds_read_b128 v[84:87], v77 offset:33552
    s_mov_b32 s61, 0x01000100
    s_mov_b32 s62, 0x03020302
    s_waitcnt lgkmcnt(0)
    v_perm_b32 v36, v80, v80, s61
    v_and_b32 v28, v36, v6
    v_and_b32 v29, v36, v7
    v_and_b32 v30, v36, v8
    v_and_b32 v31, v36, v9
    v_perm_b32 v36, v80, v80, s62
    v_and_b32 v32, v36, v6
    v_and_b32 v33, v36, v7
    v_and_b32 v34, v36, v8
    v_and_b32 v35, v36, v9
    v_mfma_f32_16x16x32_bf16 v[40:43], v[28:31], v[176:179], 0
    v_perm_b32 v36, v81, v81, s61
    v_and_b32 v28, v36, v6
    v_and_b32 v29, v36, v7
    v_and_b32 v30, v36, v8
    v_and_b32 v31, v36, v9
    v_mfma_f32_16x16x32_bf16 v[40:43], v[32:35], v[180:183], v[40:43]
    v_perm_b32 v36, v81, v81, s62
    v_and_b32 v32, v36, v6
    v_and_b32 v33, v36, v7
    v_and_b32 v34, v36, v8
    v_and_b32 v35, v36, v9
    v_mfma_f32_16x16x32_bf16 v[40:43], v[28:31], v[184:187], v[40:43]
    v_perm_b32 v36, v82, v82, s61
    v_and_b32 v28, v36, v6
    v_and_b32 v29, v36, v7
    v_and_b32 v30, v36, v8
    v_and_b32 v31, v36, v9
    v_mfma_f32_16x16x32_bf16 v[40:43], v[32:35], v[188:191], v[40:43]
    v_perm_b32 v36, v82, v82, s62
    v_and_b32 v32, v36, v6
    v_and_b32 v33, v36, v7
    v_and_b32 v34, v36, v8
    v_and_b32 v35, v36, v9
    v_mfma_f32_16x16x32_bf16 v[40:43], v[28:31], v[192:195], v[40:43]
    v_perm_b32 v36, v83, v83, s61
    v_and_b32 v28, v36, v6
    v_and_b32 v29, v36, v7
    v_and_b32 v30, v36, v8
    v_and_b32 v31, v36, v9
    v_mfma_f32_16x16x32_bf16 v[40:43], v[32:35], v[196:199], v[40:43]
    v_perm_b32 v36, v83, v83, s62
    v_and_b32 v32, v36, v6
    v_and_b32 v33, v36, v7
    v_and_b32 v34, v36, v8
    v_and_b32 v35, v36, v9
    v_mfma_f32_16x16x32_bf16 v[40:43], v[28:31], v[200:203], v[40:43]
    v_perm_b32 v36, v84, v84, s61
    v_and_b32 v28, v36, v6
    v_and_b32 v29, v36, v7
    v_and_b32 v30, v36, v8
    v_and_b32 v31, v36, v9
    v_mfma_f32_16x16x32_bf16 v[40:43], v[32:35], v[204:207], v[40:43]
    v_perm_b32 v36, v84, v84, s62
    v_and_b32 v32, v36, v6
    v_and_b32 v33, v36, v7
    v_and_b32 v34, v36, v8
    v_and_b32 v35, v36, v9
    v_mfma_f32_16x16x32_bf16 v[40:43], v[28:31], v[208:211], v[40:43]
    v_perm_b32 v36, v85, v85, s61
    v_and_b32 v28, v36, v6
    v_and_b32 v29, v36, v7
    v_and_b32 v30, v36, v8
    v_and_b32 v31, v36, v9
    v_mfma_f32_16x16x32_bf16 v[40:43], v[32:35], v[212:215], v[40:43]
    v_perm_b32 v36, v85, v85, s62
    v_and_b32 v32, v36, v6
    v_and_b32 v33, v36, v7
    v_and_b32 v34, v36, v8
    v_and_b32 v35, v36, v9
    v_mfma_f32_16x16x32_bf16 v[40:43], v[28:31], v[216:219], v[40:43]
    v_perm_b32 v36, v86, v86, s61
    v_and_b32 v28, v36, v6
    v_and_b32 v29, v36, v7
    v_and_b32 v30, v36, v8
    v_and_b32 v31, v36, v9
    v_mfma_f32_16x16x32_bf16 v[40:43], v[32:35], v[220:223], v[40:43]
    v_perm_b32 v36, v86, v86, s62
    v_and_b32 v32, v36, v6
    v_and_b32 v33, v36, v7
    v_and_b32 v34, v36, v8
    v_and_b32 v35, v36, v9
    v_mfma_f32_16x16x32_bf16 v[40:43], v[28:31], v[224:227], v[40:43]
    v_perm_b32 v36, v87, v87, s61
    v_and_b32 v28, v36, v6
    v_and_b32 v29, v36, v7
    v_and_b32 v30, v36, v8
    v_and_b32 v31, v36, v9
    v_mfma_f32_16x16x32_bf16 v[40:43], v[32:35], v[228:231], v[40:43]
    v_perm_b32 v36, v87, v87, s62
    v_and_b32 v32, v36, v6
    v_and_b32 v33, v36, v7
    v_and_b32 v34, v36, v8
    v_and_b32 v35, v36, v9
    v_mfma_f32_16x16x32_bf16 v[40:43], v[28:31], v[232:235], v[40:43]
    s_nop 0
    v_mfma_f32_16x16x32_bf16 v[40:43], v[32:35], v[236:239], v[40:43]
    s_mul_i32 s62, s77, 5
    s_sub_u32 s62, s83, s62
    s_lshl_b32 s62, s62, 10
    s_mul_i32 s61, s77, 64512
    s_add_u32 s61, s61, s62
    s_add_u32 s61, s61, 5120
    s_nop 5
    v_and_or_b32 v40, v40, -16, s16
    v_and_or_b32 v41, v41, -16, s17
    v_and_or_b32 v42, v42, -16, s18
    v_and_or_b32 v43, v43, -16, s19
    buffer_store_dwordx4 v[40:43], v2, s[40:43], s61 offen sc1
    s_mov_b32 s3, 4
    s_setprio 1
    s_branch L_exl
L_code_end:
.section .rodata,"a"
.p2align 6
.amdhsa_kernel parallel_sum__gqa_block_cached__geglu_ffn__decode_kernel
  .amdhsa_next_free_vgpr 256
  .amdhsa_next_free_sgpr 102
  .amdhsa_accum_offset 256
  .amdhsa_group_segment_fixed_size 0
  .amdhsa_kernarg_size 96
  .amdhsa_user_sgpr_count 2
  .amdhsa_user_sgpr_kernarg_segment_ptr 1
  .amdhsa_system_sgpr_workgroup_id_x 1
  .amdhsa_float_denorm_mode_32 3
.end_amdhsa_kernel
```
